```python
import torch

def _softmax(x, axis=-1):
    return torch.softmax(x, dim=axis)
def _gelu(x):
    return torch.nn.functional.gelu(x, approximate="tanh")
def _silu(x):
    return torch.nn.functional.silu(x)
def _sigmoid(x):
    return torch.sigmoid(x)
def _layernorm(x, axis=-1, eps=1e-5):
    m = x.mean(dim=axis, keepdim=True)
    v = x.var(dim=axis, keepdim=True, unbiased=False)
    return (x - m) / torch.sqrt(v + eps)
def _scatter_add(tgt, idx, src, axis=0):
    return tgt.clone().index_add_(axis, idx, src)
def _segment_sum(src, seg, n):
    out = torch.zeros((n,) + src.shape[1:], dtype=src.dtype)
    return out.index_add_(0, seg, src)
def _pad(x, pw):
    flat = tuple(v for pair in reversed(pw) for v in pair)
    return torch.nn.functional.pad(x, flat)

kernel_name = 'interleave_layers__gqa_block_cached__geglu_ffn__decode'

def setup_inputs():

    _w = (lambda a: (lambda t: t.to(torch.bfloat16) if t.is_floating_point() else t)(torch.as_tensor(a)))
    def _A_setup():
        B, Sq, D = 4, 1, 448
        Hq, Hkv, Sk, Dh = 16, 8, 4096, 256
        assert Hq % Hkv == 0, (Hq, Hkv)
        return {
            "x": _w((lambda *s: torch.randn(*s, dtype=torch.bfloat16) * 0.05)(B, Sq, D)),
            "k_cache": _w((lambda *s: torch.randn(*s, dtype=torch.bfloat16) * 1.6)(B, Hkv, Sk, Dh)),
            "v_cache": _w((lambda *s: torch.randn(*s, dtype=torch.bfloat16) * 1.6)(B, Hkv, Sk, Dh)),
            "wq": _w((lambda *s: torch.randn(*s, dtype=torch.bfloat16) * 1.6)(D, Hq * Dh) * (D ** -0.5)),
            "wo": _w((lambda *s: torch.randn(*s, dtype=torch.bfloat16) * 1.6)(Hq * Dh, D) * ((Hq * Dh) ** -0.5)),
        }
    _A_in = _A_setup()

    def _B_setup():
        B, S, D, F = 4, 1, 448, 1792
        return {
            "x": _w((lambda *s: torch.randn(*s, dtype=torch.bfloat16) * 0.05)(B, S, D)),
            "w_gate": _w((lambda *s: torch.randn(*s, dtype=torch.bfloat16) * 0.05)(D, F)),
            "w_up": _w((lambda *s: torch.randn(*s, dtype=torch.bfloat16) * 0.05)(D, F)),
            "w_down": _w((lambda *s: torch.randn(*s, dtype=torch.bfloat16) * 0.05)(F, D)),
        }
    _B_in = _B_setup()

    return {
        "A_x": _A_in["x"],
        "A_k_cache": _A_in["k_cache"],
        "A_v_cache": _A_in["v_cache"],
        "A_wq": _A_in["wq"],
        "A_wo": _A_in["wo"],
        "B_x": _B_in["x"],
        "B_w_gate": _B_in["w_gate"],
        "B_w_up": _B_in["w_up"],
        "B_w_down": _B_in["w_down"],
    }

def reference(A_x, A_k_cache, A_v_cache, A_wq, A_wo, B_x, B_w_gate, B_w_up, B_w_down):
    def _A_ref(x, k_cache, v_cache, wq, wo):
        B, Sq, D = x.shape
        Hq, Dh = 16, 256
        Hkv = k_cache.shape[1]
        rep = Hq // Hkv
        q = (lambda x, *d: x.permute(*d))((x @ wq).reshape(B, Sq, Hq, Dh), 0, 2, 1, 3)
        k = (lambda x, n, axis: torch.repeat_interleave(x, n, dim=axis))(k_cache, rep, axis=1)
        v = (lambda x, n, axis: torch.repeat_interleave(x, n, dim=axis))(v_cache, rep, axis=1)
        scores = torch.einsum("bhqd,bhkd->bhqk", q, k) * (Dh ** -0.5)
        p = _softmax(scores, axis=-1)
        o = torch.einsum("bhqk,bhkd->bhqd", p, v)
        return (lambda x, *d: x.permute(*d))(o, 0, 2, 1, 3).reshape(B, Sq, Hq * Dh) @ wo

    def _B_ref(x, w_gate, w_up, w_down):
        return (_gelu(x @ w_gate) * (x @ w_up)) @ w_down

    x = A_x
    x = x + _A_ref(_layernorm(x, axis=-1), A_k_cache, A_v_cache, A_wq, A_wo)
    x = x + _B_ref(_layernorm(x, axis=-1), B_w_gate, B_w_up, B_w_down)
    x = x + _A_ref(_layernorm(x, axis=-1), A_k_cache, A_v_cache, A_wq, A_wo)
    x = x + _B_ref(_layernorm(x, axis=-1), B_w_gate, B_w_up, B_w_down)
    return x
```

```asm
; @launch grid=(256,1,1) block=(256,1,1) lds=163840
.amdgcn_target "amdgcn-amd-amdhsa--gfx950"
.text
.globl interleave_layers__gqa_block_cached__geglu_ffn__decode_kernel
.p2align 8
.type interleave_layers__gqa_block_cached__geglu_ffn__decode_kernel,@function
interleave_layers__gqa_block_cached__geglu_ffn__decode_kernel:
    s_cmp_ge_u32 s2, 256
    s_cbranch_scc1 Lend
    s_load_dwordx16 s[16:31], s[0:1], 0
    s_load_dwordx8 s[32:39], s[0:1], 64
    v_lshrrev_b32 v1, 6, v0
    s_and_b32 s4, s2, 7
    v_readfirstlane_b32 s7, v1
    s_lshr_b32 s13, s2, 3
    s_and_b32 s5, s13, 3
    s_lshr_b32 s6, s2, 5
    s_mov_b32 s3, 0
    v_and_b32 v1, 15, v0
    v_bfe_u32 v2, v0, 4, 2
    v_lshlrev_b32 v4, 9, v1
    v_lshl_add_u32 v4, v2, 4, v4
    v_lshlrev_b32 v5, 11, v2
    v_lshl_add_u32 v5, v1, 4, v5
    s_mov_b32 s62, s4
    s_and_b32 s62, s13, 7
    s_lshr_b32 s5, s2, 6
    s_mov_b32 s6, s4
    s_lshl_b32 s8, s5, 3
    s_add_u32 s8, s8, s62
    s_lshl_b32 s9, s8, 21
    s_lshl_b32 s80, s7, 13
    s_lshl_b32 s10, s6, 15
    s_add_u32 s80, s80, s10
    s_mul_i32 s81, s7, 36864
    s_add_u32 s81, s81, 12288
    s_lshl_b32 s84, s8, 13
    s_lshl_b32 s10, s6, 10
    s_add_u32 s84, s84, s10
    s_lshl_b32 s85, s8, 7
    s_lshl_b32 s10, s6, 3
    s_add_u32 s85, s85, s10
    s_add_u32 s85, s85, 0x5c000
    s_mov_b32 s86, 0
    s_mov_b32 s82, 0x100000
    s_lshl_b32 s11, s7, 4
    s_lshl_b32 s83, s2, 7
    s_lshl_b32 s10, s7, 5
    s_add_u32 s83, s83, s10
    s_sub_u32 s87, s2, 64
    s_lshr_b32 s87, s87, 1
    s_lshl_b32 s63, s87, 7
    s_add_u32 s87, s63, s10
    s_bitcmp1_b32 s2, 0
    s_cselect_b32 s10, 0, 0x14000
    s_add_u32 s87, s87, s10
    s_add_u32 s87, s87, 0x40000
    s_max_u32 s14, s13, 15
    s_sub_u32 s14, s14, 15
    s_min_u32 s14, s14, 13
    s_cmp_ge_u32 s14, 7
    s_cselect_b32 s88, 1, 0
    s_mul_i32 s10, s88, 7
    s_sub_u32 s14, s14, s10
    s_lshl_b32 s89, s14, 6
    s_add_u32 s89, s89, s11
    s_mov_b32 s12, 0
    s_cmp_ge_u32 s13, 8
    s_cselect_b32 s12, 1, s12
    s_cmp_ge_u32 s13, 15
    s_cselect_b32 s12, 2, s12
    s_cmp_ge_u32 s13, 29
    s_cselect_b32 s12, 3, s12
    s_mov_b32 s99, 0x3db8aa3b
    s_and_b32 s15, s13, 0
    s_lshl_b32 s15, s15, 14
    s_lshl_b32 s10, s7, 12
    s_add_u32 s15, s15, s10
    s_and_b32 s56, s2, 1
    s_lshl_b32 s56, s56, 12
    s_mov_b32 s97, 0x2f800000
    s_mov_b32 s96, 0x4f800000
    s_movk_i32 s95, 0xffe0
    s_waitcnt lgkmcnt(0)
    s_add_u32 s40, s18, s9
    s_addc_u32 s41, s19, 0
    s_mov_b32 s42, 0x200000
    s_mov_b32 s43, 0x00020000
    s_add_u32 s44, s20, s9
    s_addc_u32 s45, s21, 0
    s_mov_b32 s46, 0x200000
    s_mov_b32 s47, 0x00020000
    s_mov_b32 s64, s38
    s_mov_b32 s65, s39
    s_mov_b32 s66, 0x400000
    s_mov_b32 s67, 0x00020000
    s_mov_b32 s68, s16
    s_mov_b32 s69, s17
    s_mov_b32 s70, 0xe00
    s_mov_b32 s71, 0x00020000
    s_mov_b32 s72, s34
    s_mov_b32 s73, s35
    s_mov_b32 s74, 0xe00
    s_mov_b32 s75, 0x00020000
    s_mov_b32 s76, s36
    s_mov_b32 s77, s37
    s_mov_b32 s78, 0x100
    s_mov_b32 s79, 0x00020000
    s_cmp_lt_u32 s13, 22
    s_cbranch_scc1 Lth
    s_sleep 25
    s_cmp_lt_u32 s13, 29
    s_cbranch_scc1 Lth
    s_sleep 25
Lth:
    v_and_b32 v15, 63, v0
    v_lshlrev_b32 v1, 4, v15
    v_min_u32 v2, 47, v15
    v_lshlrev_b32 v2, 4, v2
    v_add_u32 v2, 1024, v2
    s_mul_i32 s8, s7, 896
    s_add_u32 s8, s8, 12544
    v_lshrrev_b32 v3, 1, v1
    v_add_u32 v3, s8, v3
    v_lshrrev_b32 v14, 1, v2
    v_add_u32 v14, s8, v14
    v_lshrrev_b32 v6, 1, v1
    v_lshrrev_b32 v7, 1, v2
    s_mul_i32 s8, s7, 896
    buffer_load_dwordx2 v[8:9], v6, s[68:71], s8 offen
    buffer_load_dwordx2 v[10:11], v7, s[68:71], s8 offen
    v_and_b32 v15, 63, v0
    v_lshrrev_b32 v12, 3, v15
    v_and_b32 v13, 7, v15
    v_xor_b32 v16, 0, v13
    v_xor_b32 v17, 2, v13
    v_xor_b32 v18, 4, v13
    v_xor_b32 v19, 6, v13
    s_mov_b32 s48, s22
    s_mov_b32 s49, s23
    s_mov_b32 s50, 0x380000
    s_mov_b32 s51, 0x00020000
    s_lshl_b32 s92, s2, 7
    s_movk_i32 s93, 8192
    s_lshl_b32 s10, s7, 7
    s_cmp_eq_u32 s12, 0
    s_cbranch_scc1 Lwsel
    s_bitcmp1_b32 s2, 0
    s_cselect_b32 s48, s30, s28
    s_cselect_b32 s49, s31, s29
    s_mov_b32 s50, 0x188000
    s_mov_b32 s92, s63
    s_movk_i32 s93, 3584
    s_cmp_eq_u32 s12, 1
    s_cbranch_scc1 Lwsel
    s_movk_i32 s93, 896
    s_and_b32 s10, s7, 1
    s_lshl_b32 s10, s10, 7
    s_mov_b32 s48, s24
    s_mov_b32 s49, s25
    s_mov_b32 s50, 0x380000
    s_lshl_b32 s8, s4, 1
    s_add_u32 s8, s8, s88
    s_mul_i32 s92, s8, 229376
    s_lshl_b32 s8, s14, 7
    s_add_u32 s92, s92, s8
    s_cmp_eq_u32 s12, 3
    s_cselect_b32 s50, 0, s50
    s_cmp_lt_u32 s7, 2
    s_cbranch_scc1 Lwsel
    s_mov_b32 s48, s32
    s_mov_b32 s49, s33
    s_add_u32 s50, s4, 1
    s_mul_i32 s50, s50, 200704
    s_cmp_lg_u32 s88, 0
    s_cselect_b32 s50, 0, s50
    s_mul_i32 s92, s4, 200704
    s_add_u32 s92, s92, s8
Lwsel:
    s_mov_b32 s52, s48
    s_mov_b32 s53, s49
    s_lshl_b32 s94, s93, 3
Lwsel2:
    s_mov_b32 s54, s50
    s_mov_b32 s55, 0x00020000
    s_mul_i32 s10, s10, s93
    s_add_u32 s92, s92, s10
    s_add_u32 s94, s94, s92
    v_mul_lo_u32 v12, v12, s93
    s_lshl_b32 s93, s93, 4
    v_lshl_add_u32 v16, v16, 4, v12
    v_lshl_add_u32 v17, v17, 4, v12
    v_lshl_add_u32 v18, v18, 4, v12
    v_lshl_add_u32 v19, v19, 4, v12
    s_lshl_b32 s11, s7, 14
    s_add_u32 s11, s11, 16384
    s_add_u32 m0, s11, 0
    s_nop 0
    buffer_load_dwordx4 v16, s[48:51], s92 offen nt lds
    s_add_u32 m0, s11, 1024
    s_nop 0
    buffer_load_dwordx4 v17, s[52:55], s94 offen nt lds
    s_add_u32 s92, s92, s93
    s_add_u32 s94, s94, s93
    s_add_u32 m0, s11, 2048
    s_nop 0
    buffer_load_dwordx4 v18, s[48:51], s92 offen nt lds
    s_add_u32 m0, s11, 3072
    s_nop 0
    buffer_load_dwordx4 v19, s[52:55], s94 offen nt lds
    s_add_u32 s92, s92, s93
    s_add_u32 s94, s94, s93
    s_add_u32 m0, s11, 4096
    s_nop 0
    buffer_load_dwordx4 v16, s[48:51], s92 offen nt lds
    s_add_u32 m0, s11, 5120
    s_nop 0
    buffer_load_dwordx4 v17, s[52:55], s94 offen nt lds
    s_add_u32 s92, s92, s93
    s_add_u32 s94, s94, s93
    s_add_u32 m0, s11, 6144
    s_nop 0
    buffer_load_dwordx4 v18, s[48:51], s92 offen nt lds
    s_add_u32 m0, s11, 7168
    s_nop 0
    buffer_load_dwordx4 v19, s[52:55], s94 offen nt lds
    s_add_u32 s92, s92, s93
    s_add_u32 s94, s94, s93
    s_and_b32 s8, s2, 0x60
    s_cmp_eq_u32 s8, 0x60
    s_cselect_b32 s8, 0, -1
    v_mov_b32 v24, s8
    v_mov_b32 v25, s8
    v_mov_b32 v26, s8
    v_mov_b32 v27, s8
    v_lshlrev_b32 v7, 4, v0
    s_lshl_b32 s8, s2, 12
    buffer_store_dwordx4 v[24:27], v7, s[64:67], s8 offen sc1
    s_cmp_lg_u32 s12, 0
    s_cbranch_scc1 Lnoclrq
    v_bfe_u32 v12, v0, 4, 2
    v_and_b32 v13, 15, v0
    v_lshlrev_b32 v12, 13, v12
    v_lshl_add_u32 v12, v13, 1, v12
    s_add_u32 s8, s82, s83
    s_mov_b32 exec_lo, 0x55555555
    s_mov_b32 exec_hi, 0x55555555
    buffer_store_dword v24, v12, s[64:67], s8 offen sc1
    s_mov_b64 exec, -1
Lnoclrq:
    s_add_u32 m0, s11, 8192
    s_nop 0
    buffer_load_dwordx4 v16, s[48:51], s92 offen nt lds
    s_add_u32 m0, s11, 9216
    s_nop 0
    buffer_load_dwordx4 v17, s[52:55], s94 offen nt lds
    s_add_u32 s92, s92, s93
    s_add_u32 s94, s94, s93
    s_add_u32 m0, s11, 10240
    s_nop 0
    buffer_load_dwordx4 v18, s[48:51], s92 offen nt lds
    s_add_u32 m0, s11, 11264
    s_nop 0
    buffer_load_dwordx4 v19, s[52:55], s94 offen nt lds
    s_add_u32 s92, s92, s93
    s_add_u32 s94, s94, s93
    s_add_u32 m0, s11, 12288
    s_nop 0
    buffer_load_dwordx4 v16, s[48:51], s92 offen nt lds
    s_add_u32 m0, s11, 13312
    s_nop 0
    buffer_load_dwordx4 v17, s[52:55], s94 offen nt lds
    s_add_u32 s92, s92, s93
    s_add_u32 s94, s94, s93
    s_add_u32 m0, s11, 14336
    s_nop 0
    buffer_load_dwordx4 v18, s[48:51], s92 offen nt lds
    s_add_u32 m0, s11, 15360
    s_nop 0
    buffer_load_dwordx4 v19, s[52:55], s94 offen nt lds
    s_add_u32 s10, s80, 0
    buffer_load_dwordx4 a[0:3], v4, s[40:43], s10 offen offset:0 nt
    s_add_u32 s10, s80, 0
    buffer_load_dwordx4 a[4:7], v4, s[40:43], s10 offen offset:64 nt
    s_add_u32 s10, s80, 0
    buffer_load_dwordx4 a[8:11], v4, s[40:43], s10 offen offset:128 nt
    s_add_u32 s10, s80, 0
    buffer_load_dwordx4 a[12:15], v4, s[40:43], s10 offen offset:192 nt
    s_add_u32 s10, s80, 0
    buffer_load_dwordx4 a[16:19], v4, s[40:43], s10 offen offset:256 nt
    s_add_u32 s10, s80, 0
    buffer_load_dwordx4 a[20:23], v4, s[40:43], s10 offen offset:320 nt
    v_mov_b32 v6, 0
    ds_write_b32 v6, v6 offset:16256
    s_waitcnt vmcnt(23)
    v_lshlrev_b32 v16, 16, v8
    v_and_b32 v17, 0xffff0000, v8
    v_lshlrev_b32 v18, 16, v9
    v_and_b32 v19, 0xffff0000, v9
    v_lshlrev_b32 v20, 16, v10
    v_and_b32 v21, 0xffff0000, v10
    v_lshlrev_b32 v22, 16, v11
    v_and_b32 v23, 0xffff0000, v11
    ds_write_b64 v3, v[8:9]
    ds_write_b64 v14, v[10:11]
    s_waitcnt lgkmcnt(0)
    s_cmp_lg_u32 s12, 0
    s_cbranch_scc1 Lpro2
    v_add_f32 v24, v16, v17
    v_add_f32 v26, v18, v19
    v_mul_f32 v25, v16, v16
    v_add_f32 v24, v24, v26
    v_fmac_f32 v25, v17, v17
    v_fmac_f32 v25, v18, v18
    v_fmac_f32 v25, v19, v19
    s_mov_b32 exec_hi, 0xffff
    v_add_f32 v24, v24, v20
    v_fmac_f32 v25, v20, v20
    v_add_f32 v24, v24, v21
    v_fmac_f32 v25, v21, v21
    v_add_f32 v24, v24, v22
    v_fmac_f32 v25, v22, v22
    v_add_f32 v24, v24, v23
    v_fmac_f32 v25, v23, v23
    s_mov_b32 exec_hi, -1
    s_nop 1
    v_add_f32_dpp v24, v24, v24 row_shr:1 row_mask:0xf bank_mask:0xf bound_ctrl:0
    v_add_f32_dpp v25, v25, v25 row_shr:1 row_mask:0xf bank_mask:0xf bound_ctrl:0
    s_nop 0
    v_add_f32_dpp v24, v24, v24 row_shr:2 row_mask:0xf bank_mask:0xf bound_ctrl:0
    v_add_f32_dpp v25, v25, v25 row_shr:2 row_mask:0xf bank_mask:0xf bound_ctrl:0
    s_nop 0
    v_add_f32_dpp v24, v24, v24 row_shr:4 row_mask:0xf bank_mask:0xf bound_ctrl:0
    v_add_f32_dpp v25, v25, v25 row_shr:4 row_mask:0xf bank_mask:0xf bound_ctrl:0
    s_nop 0
    v_add_f32_dpp v24, v24, v24 row_shr:8 row_mask:0xf bank_mask:0xf bound_ctrl:0
    v_add_f32_dpp v25, v25, v25 row_shr:8 row_mask:0xf bank_mask:0xf bound_ctrl:0
    s_nop 0
    v_add_f32_dpp v24, v24, v24 row_bcast:15 row_mask:0xa bank_mask:0xf
    v_add_f32_dpp v25, v25, v25 row_bcast:15 row_mask:0xa bank_mask:0xf
    s_nop 0
    v_add_f32_dpp v24, v24, v24 row_bcast:31 row_mask:0xc bank_mask:0xf
    v_add_f32_dpp v25, v25, v25 row_bcast:31 row_mask:0xc bank_mask:0xf
    s_nop 0
    v_readlane_b32 s8, v24, 63
    v_readlane_b32 s9, v25, 63
    s_mul_i32 s10, s7, 1088
    s_add_u32 s10, s10, 0
    v_mov_b32 v26, 0x3b124925
    v_mul_f32 v24, s8, v26
    v_mul_f32 v25, s9, v26
    v_fma_f32 v25, -v24, v24, v25
    v_max_f32 v25, 0, v25
    v_cvt_pk_bf16_f32 v26, v24, v25
    v_lshlrev_b32 v24, 16, v26
    v_and_b32 v25, 0xffff0000, v26
    v_add_f32 v25, 0x3727c5ac, v25
    v_cvt_pk_bf16_f32 v25, v25, v25
    v_lshlrev_b32 v25, 16, v25
    v_sqrt_f32 v25, v25
    v_sub_f32 v16, v16, v24
    v_sub_f32 v17, v17, v24
    v_sub_f32 v18, v18, v24
    v_sub_f32 v19, v19, v24
    v_sub_f32 v20, v20, v24
    v_sub_f32 v21, v21, v24
    v_sub_f32 v22, v22, v24
    v_sub_f32 v23, v23, v24
    v_cvt_pk_bf16_f32 v25, v25, v25
    v_lshlrev_b32 v25, 16, v25
    v_rcp_f32 v25, v25
    v_cvt_pk_bf16_f32 v26, v16, v17
    v_lshlrev_b32 v16, 16, v26
    v_and_b32 v17, 0xffff0000, v26
    v_cvt_pk_bf16_f32 v26, v18, v19
    v_lshlrev_b32 v18, 16, v26
    v_and_b32 v19, 0xffff0000, v26
    v_cvt_pk_bf16_f32 v26, v20, v21
    v_lshlrev_b32 v20, 16, v26
    v_and_b32 v21, 0xffff0000, v26
    v_cvt_pk_bf16_f32 v26, v22, v23
    v_lshlrev_b32 v22, 16, v26
    v_and_b32 v23, 0xffff0000, v26
    v_mul_f32 v16, v16, v25
    v_mul_f32 v17, v17, v25
    v_mul_f32 v18, v18, v25
    v_mul_f32 v19, v19, v25
    v_mul_f32 v20, v20, v25
    v_mul_f32 v21, v21, v25
    v_mul_f32 v22, v22, v25
    v_mul_f32 v23, v23, v25
    v_cvt_pk_bf16_f32 v24, v16, v17
    v_cvt_pk_bf16_f32 v25, v18, v19
    v_cvt_pk_bf16_f32 v26, v20, v21
    v_cvt_pk_bf16_f32 v27, v22, v23
    v_lshrrev_b32 v1, 1, v1
    v_add_u32 v1, s10, v1
    v_lshrrev_b32 v2, 1, v2
    v_add_u32 v2, s10, v2
    ds_write_b64 v1, v[24:25]
    ds_write_b64 v2, v[26:27]
    s_add_u32 s10, s80, 0
    buffer_load_dwordx4 a[24:27], v4, s[40:43], s10 offen offset:384 nt
    s_add_u32 s10, s80, 0
    buffer_load_dwordx4 a[28:31], v4, s[40:43], s10 offen offset:448 nt
    s_add_u32 s10, s80, 262144
    buffer_load_dwordx4 a[32:35], v4, s[40:43], s10 offen offset:0 nt
    s_add_u32 s10, s80, 262144
    buffer_load_dwordx4 a[36:39], v4, s[40:43], s10 offen offset:64 nt
    s_add_u32 s10, s80, 262144
    buffer_load_dwordx4 a[40:43], v4, s[40:43], s10 offen offset:128 nt
    s_add_u32 s10, s80, 262144
    buffer_load_dwordx4 a[44:47], v4, s[40:43], s10 offen offset:192 nt
    v_bfe_u32 v12, v0, 4, 2
    v_bfe_u32 v13, v0, 2, 2
    v_xor_b32 v7, s7, v12
    v_and_b32 v15, 3, v0
    v_lshl_add_u32 v6, v12, 3, v13
    v_lshlrev_b32 v6, 7, v6
    v_lshl_add_u32 v6, v7, 5, v6
    v_lshl_add_u32 v6, v15, 3, v6
    v_add_u32 v16, 512, v6
    v_add_u32 v6, 16384, v6
    v_add_u32 v16, 16384, v16
    s_waitcnt vmcnt(12)
    s_barrier
    s_cmp_lg_u32 s7, 0
    s_cbranch_scc1 Lwk4
    s_mov_b64 exec, 1
    s_add_u32 s9, s4, 8
    s_cmp_eq_u32 s12, 0
    s_cselect_b32 s9, s13, s9
    s_lshl_b32 s9, s9, 4
    v_mov_b32 v25, 1
    v_mov_b32 v26, 0
    buffer_atomic_add v25, v26, s[76:79], s9 offen sc1
    s_mov_b64 exec, -1
Lwk4:
    ds_read_b64_tr_b16 v[80:81], v6 offset:0
    ds_read_b64_tr_b16 v[82:83], v16 offset:0
    ds_read_b64_tr_b16 v[84:85], v6 offset:4096
    ds_read_b64_tr_b16 v[86:87], v16 offset:4096
    ds_read_b64_tr_b16 v[88:89], v6 offset:8192
    ds_read_b64_tr_b16 v[90:91], v16 offset:8192
    ds_read_b64_tr_b16 v[92:93], v6 offset:12288
    ds_read_b64_tr_b16 v[94:95], v16 offset:12288
    s_waitcnt lgkmcnt(4)
    ds_read_b64_tr_b16 v[96:97], v6 offset:16384
    ds_read_b64_tr_b16 v[98:99], v16 offset:16384
    ds_read_b64_tr_b16 v[100:101], v6 offset:20480
    ds_read_b64_tr_b16 v[102:103], v16 offset:20480
    ds_read_b64_tr_b16 v[104:105], v6 offset:24576
    ds_read_b64_tr_b16 v[106:107], v16 offset:24576
    ds_read_b64_tr_b16 v[108:109], v6 offset:28672
    ds_read_b64_tr_b16 v[110:111], v16 offset:28672
    s_waitcnt lgkmcnt(4)
    ds_read_b64_tr_b16 v[112:113], v6 offset:32768
    ds_read_b64_tr_b16 v[114:115], v16 offset:32768
    ds_read_b64_tr_b16 v[116:117], v6 offset:36864
    ds_read_b64_tr_b16 v[118:119], v16 offset:36864
    ds_read_b64_tr_b16 v[120:121], v6 offset:40960
    ds_read_b64_tr_b16 v[122:123], v16 offset:40960
    ds_read_b64_tr_b16 v[124:125], v6 offset:45056
    ds_read_b64_tr_b16 v[126:127], v16 offset:45056
    s_waitcnt lgkmcnt(4)
    ds_read_b64_tr_b16 v[128:129], v6 offset:49152
    ds_read_b64_tr_b16 v[130:131], v16 offset:49152
    ds_read_b64_tr_b16 v[132:133], v6 offset:53248
    ds_read_b64_tr_b16 v[134:135], v16 offset:53248
    ds_read_b64_tr_b16 v[136:137], v6 offset:57344
    ds_read_b64_tr_b16 v[138:139], v16 offset:57344
    ds_read_b64_tr_b16 v[140:141], v6 offset:61440
    ds_read_b64_tr_b16 v[142:143], v16 offset:61440
    s_add_u32 s10, s80, 262144
    buffer_load_dwordx4 a[48:51], v4, s[40:43], s10 offen offset:256 nt
    s_add_u32 s10, s80, 262144
    buffer_load_dwordx4 a[52:55], v4, s[40:43], s10 offen offset:320 nt
    s_add_u32 s10, s80, 262144
    buffer_load_dwordx4 a[56:59], v4, s[40:43], s10 offen offset:384 nt
    s_add_u32 s10, s80, 262144
    buffer_load_dwordx4 a[60:63], v4, s[40:43], s10 offen offset:448 nt
    v_bfe_u32 v1, v0, 2, 2
    v_mul_u32_u24 v1, 1088, v1
    v_bfe_u32 v2, v0, 4, 2
    v_lshl_add_u32 v1, v2, 4, v1
    s_waitcnt lgkmcnt(0)
    s_barrier
    ds_read_b128 v[32:35], v1 offset:0
    ds_read_b128 v[36:39], v1 offset:64
    ds_read_b128 v[40:43], v1 offset:128
    ds_read_b128 v[44:47], v1 offset:192
    ds_read_b128 v[48:51], v1 offset:256
    ds_read_b128 v[52:55], v1 offset:320
    ds_read_b128 v[56:59], v1 offset:384
    ds_read_b128 v[60:63], v1 offset:448
    s_waitcnt lgkmcnt(7)
    v_mfma_f32_16x16x32_bf16 v[24:27], v[32:35], v[80:83], 0
    ds_read_b128 v[32:35], v1 offset:512
    s_waitcnt lgkmcnt(7)
    v_mfma_f32_16x16x32_bf16 v[28:31], v[36:39], v[84:87], 0
    ds_read_b128 v[36:39], v1 offset:576
    s_waitcnt lgkmcnt(7)
    v_mfma_f32_16x16x32_bf16 v[24:27], v[40:43], v[88:91], v[24:27]
    ds_read_b128 v[40:43], v1 offset:640
    s_waitcnt lgkmcnt(7)
    v_mfma_f32_16x16x32_bf16 v[28:31], v[44:47], v[92:95], v[28:31]
    ds_read_b128 v[44:47], v1 offset:704
    s_waitcnt lgkmcnt(7)
    v_mfma_f32_16x16x32_bf16 v[24:27], v[48:51], v[96:99], v[24:27]
    ds_read_b128 v[48:51], v1 offset:768
    s_waitcnt lgkmcnt(7)
    v_mfma_f32_16x16x32_bf16 v[28:31], v[52:55], v[100:103], v[28:31]
    ds_read_b128 v[52:55], v1 offset:832
    s_waitcnt lgkmcnt(7)
    v_mfma_f32_16x16x32_bf16 v[24:27], v[56:59], v[104:107], v[24:27]
    s_waitcnt lgkmcnt(6)
    v_mfma_f32_16x16x32_bf16 v[28:31], v[60:63], v[108:111], v[28:31]
    s_waitcnt lgkmcnt(5)
    v_mfma_f32_16x16x32_bf16 v[24:27], v[32:35], v[112:115], v[24:27]
    s_waitcnt lgkmcnt(4)
    v_mfma_f32_16x16x32_bf16 v[28:31], v[36:39], v[116:119], v[28:31]
    s_waitcnt lgkmcnt(3)
    v_mfma_f32_16x16x32_bf16 v[24:27], v[40:43], v[120:123], v[24:27]
    s_waitcnt lgkmcnt(2)
    v_mfma_f32_16x16x32_bf16 v[28:31], v[44:47], v[124:127], v[28:31]
    s_waitcnt lgkmcnt(1)
    v_mfma_f32_16x16x32_bf16 v[24:27], v[48:51], v[128:131], v[24:27]
    s_waitcnt lgkmcnt(0)
    v_mfma_f32_16x16x32_bf16 v[28:31], v[52:55], v[132:135], v[28:31]
    v_bfe_u32 v1, v0, 4, 2
    v_and_b32 v2, 15, v0
    s_nop 6
    v_add_f32 v24, v24, v28
    s_nop 1
    v_mov_b32_dpp v25, v24 quad_perm:[1,0,3,2] row_mask:0xf bank_mask:0xf
    v_cvt_pk_bf16_f32 v24, v24, v25
    v_min_u32 v24, -2, v24
    v_lshlrev_b32 v1, 13, v1
    v_lshl_add_u32 v1, v2, 1, v1
    s_add_u32 s8, s82, s83
    s_mov_b32 exec_lo, 0x55555555
    s_mov_b32 exec_hi, 0x55555555
    buffer_store_dword v24, v1, s[64:67], s8 offen sc1
    s_mov_b64 exec, -1
    s_add_u32 s10, s80, 524288
    buffer_load_dwordx4 a[64:67], v4, s[40:43], s10 offen offset:0 nt
    s_add_u32 s10, s80, 524288
    buffer_load_dwordx4 a[68:71], v4, s[40:43], s10 offen offset:64 nt
    s_add_u32 s10, s80, 524288
    buffer_load_dwordx4 a[72:75], v4, s[40:43], s10 offen offset:128 nt
    s_add_u32 s10, s80, 524288
    buffer_load_dwordx4 a[76:79], v4, s[40:43], s10 offen offset:192 nt
    s_add_u32 s10, s80, 524288
    buffer_load_dwordx4 a[80:83], v4, s[40:43], s10 offen offset:256 nt
    s_add_u32 s10, s80, 524288
    buffer_load_dwordx4 a[84:87], v4, s[40:43], s10 offen offset:320 nt
    s_add_u32 s10, s80, 524288
    buffer_load_dwordx4 a[88:91], v4, s[40:43], s10 offen offset:384 nt
    s_add_u32 s10, s80, 524288
    buffer_load_dwordx4 a[92:95], v4, s[40:43], s10 offen offset:448 nt
    s_branch Lpro3
Lpro2:
    s_add_u32 s10, s80, 0
    buffer_load_dwordx4 a[24:27], v4, s[40:43], s10 offen offset:384 nt
    s_add_u32 s10, s80, 0
    buffer_load_dwordx4 a[28:31], v4, s[40:43], s10 offen offset:448 nt
    s_add_u32 s10, s80, 262144
    buffer_load_dwordx4 a[32:35], v4, s[40:43], s10 offen offset:0 nt
    s_add_u32 s10, s80, 262144
    buffer_load_dwordx4 a[36:39], v4, s[40:43], s10 offen offset:64 nt
    s_add_u32 s10, s80, 262144
    buffer_load_dwordx4 a[40:43], v4, s[40:43], s10 offen offset:128 nt
    s_add_u32 s10, s80, 262144
    buffer_load_dwordx4 a[44:47], v4, s[40:43], s10 offen offset:192 nt
    s_add_u32 s10, s80, 262144
    buffer_load_dwordx4 a[48:51], v4, s[40:43], s10 offen offset:256 nt
    s_add_u32 s10, s80, 262144
    buffer_load_dwordx4 a[52:55], v4, s[40:43], s10 offen offset:320 nt
    s_add_u32 s10, s80, 262144
    buffer_load_dwordx4 a[56:59], v4, s[40:43], s10 offen offset:384 nt
    s_add_u32 s10, s80, 262144
    buffer_load_dwordx4 a[60:63], v4, s[40:43], s10 offen offset:448 nt
    s_add_u32 s10, s80, 524288
    buffer_load_dwordx4 a[64:67], v4, s[40:43], s10 offen offset:0 nt
    s_add_u32 s10, s80, 524288
    buffer_load_dwordx4 a[68:71], v4, s[40:43], s10 offen offset:64 nt
    s_add_u32 s10, s80, 524288
    buffer_load_dwordx4 a[72:75], v4, s[40:43], s10 offen offset:128 nt
    s_add_u32 s10, s80, 524288
    buffer_load_dwordx4 a[76:79], v4, s[40:43], s10 offen offset:192 nt
    v_bfe_u32 v12, v0, 4, 2
    v_bfe_u32 v13, v0, 2, 2
    v_xor_b32 v7, s7, v12
    v_and_b32 v15, 3, v0
    v_lshl_add_u32 v6, v12, 3, v13
    v_lshlrev_b32 v6, 7, v6
    v_lshl_add_u32 v6, v7, 5, v6
    v_lshl_add_u32 v6, v15, 3, v6
    v_add_u32 v16, 512, v6
    v_add_u32 v6, 16384, v6
    v_add_u32 v16, 16384, v16
    s_waitcnt vmcnt(20)
    s_barrier
    s_cmp_lg_u32 s7, 0
    s_cbranch_scc1 Lwk8
    s_mov_b64 exec, 1
    s_add_u32 s9, s4, 8
    s_cmp_eq_u32 s12, 0
    s_cselect_b32 s9, s13, s9
    s_lshl_b32 s9, s9, 4
    v_mov_b32 v25, 1
    v_mov_b32 v26, 0
    buffer_atomic_add v25, v26, s[76:79], s9 offen sc1
    s_mov_b64 exec, -1
Lwk8:
    ds_read_b64_tr_b16 v[80:81], v6 offset:0
    ds_read_b64_tr_b16 v[82:83], v16 offset:0
    ds_read_b64_tr_b16 v[84:85], v6 offset:4096
    ds_read_b64_tr_b16 v[86:87], v16 offset:4096
    ds_read_b64_tr_b16 v[88:89], v6 offset:8192
    ds_read_b64_tr_b16 v[90:91], v16 offset:8192
    ds_read_b64_tr_b16 v[92:93], v6 offset:12288
    ds_read_b64_tr_b16 v[94:95], v16 offset:12288
    s_waitcnt lgkmcnt(4)
    ds_read_b64_tr_b16 v[96:97], v6 offset:16384
    ds_read_b64_tr_b16 v[98:99], v16 offset:16384
    ds_read_b64_tr_b16 v[100:101], v6 offset:20480
    ds_read_b64_tr_b16 v[102:103], v16 offset:20480
    ds_read_b64_tr_b16 v[104:105], v6 offset:24576
    ds_read_b64_tr_b16 v[106:107], v16 offset:24576
    ds_read_b64_tr_b16 v[108:109], v6 offset:28672
    ds_read_b64_tr_b16 v[110:111], v16 offset:28672
    s_waitcnt lgkmcnt(4)
    ds_read_b64_tr_b16 v[112:113], v6 offset:32768
    ds_read_b64_tr_b16 v[114:115], v16 offset:32768
    ds_read_b64_tr_b16 v[116:117], v6 offset:36864
    ds_read_b64_tr_b16 v[118:119], v16 offset:36864
    ds_read_b64_tr_b16 v[120:121], v6 offset:40960
    ds_read_b64_tr_b16 v[122:123], v16 offset:40960
    ds_read_b64_tr_b16 v[124:125], v6 offset:45056
    ds_read_b64_tr_b16 v[126:127], v16 offset:45056
    s_waitcnt lgkmcnt(4)
    ds_read_b64_tr_b16 v[128:129], v6 offset:49152
    ds_read_b64_tr_b16 v[130:131], v16 offset:49152
    ds_read_b64_tr_b16 v[132:133], v6 offset:53248
    ds_read_b64_tr_b16 v[134:135], v16 offset:53248
    ds_read_b64_tr_b16 v[136:137], v6 offset:57344
    ds_read_b64_tr_b16 v[138:139], v16 offset:57344
    ds_read_b64_tr_b16 v[140:141], v6 offset:61440
    ds_read_b64_tr_b16 v[142:143], v16 offset:61440
    s_add_u32 s10, s80, 524288
    buffer_load_dwordx4 a[80:83], v4, s[40:43], s10 offen offset:256 nt
    s_add_u32 s10, s80, 524288
    buffer_load_dwordx4 a[84:87], v4, s[40:43], s10 offen offset:320 nt
    s_add_u32 s10, s80, 524288
    buffer_load_dwordx4 a[88:91], v4, s[40:43], s10 offen offset:384 nt
    s_add_u32 s10, s80, 524288
    buffer_load_dwordx4 a[92:95], v4, s[40:43], s10 offen offset:448 nt
    s_waitcnt lgkmcnt(0)
    s_barrier
Lpro3:
Lloop:
    v_and_b32 v15, 63, v0
    v_lshlrev_b32 v1, 4, v15
    v_add_u32 v3, s81, v1
    v_bfe_u32 v2, v0, 3, 1
    v_lshlrev_b32 v2, 9, v2
    v_bfe_u32 v6, v0, 4, 2
    v_lshl_add_u32 v2, v6, 4, v2
    v_and_b32 v6, 1, v0
    v_cmp_eq_u32 vcc, 0, v6
    v_mov_b32 v7, 0x01000c0c
    v_mov_b32 v12, 0x0c0c0100
    v_cndmask_b32 v7, v7, v12, vcc
    v_bfe_u32 v6, v0, 1, 2
    v_mov_b32 v12, 0x0c0c0c0c
    s_mov_b32 s91, 0x02020202
    v_cmp_eq_u32 vcc, 0, v6
    s_nop 1
    v_cndmask_b32 v8, v12, v7, vcc
    v_cmp_eq_u32 vcc, 1, v6
    s_nop 1
    v_cndmask_b32 v9, v12, v7, vcc
    v_cmp_eq_u32 vcc, 2, v6
    s_nop 1
    v_cndmask_b32 v10, v12, v7, vcc
    v_cmp_eq_u32 vcc, 3, v6
    s_nop 1
    v_cndmask_b32 v11, v12, v7, vcc
    s_lshl_b32 s8, s5, 13
    s_lshl_b32 s9, s62, 10
    s_add_u32 s90, s8, s9
    s_add_u32 s90, s90, s82
    s_cmp_lg_u32 s3, 0
    s_cbranch_scc1 Lqpoll1
    v_mov_b32 v6, s62
    v_lshlrev_b32 v6, 4, v6
    s_add_u32 s10, s80, 786432
    buffer_load_dwordx4 a[96:99], v4, s[40:43], s10 offen offset:0 nt
    s_add_u32 s10, s80, 786432
    buffer_load_dwordx4 a[100:103], v4, s[40:43], s10 offen offset:64 nt
    s_add_u32 s10, s80, 786432
    buffer_load_dwordx4 a[104:107], v4, s[40:43], s10 offen offset:128 nt
    s_add_u32 s10, s80, 786432
    buffer_load_dwordx4 a[108:111], v4, s[40:43], s10 offen offset:192 nt
    s_add_u32 s10, s80, 786432
    buffer_load_dwordx4 a[112:115], v4, s[40:43], s10 offen offset:256 nt
    s_add_u32 s10, s80, 786432
    buffer_load_dwordx4 a[116:119], v4, s[40:43], s10 offen offset:320 nt
    s_add_u32 s10, s80, 786432
    buffer_load_dwordx4 a[120:123], v4, s[40:43], s10 offen offset:384 nt
    s_add_u32 s10, s80, 786432
    buffer_load_dwordx4 a[124:127], v4, s[40:43], s10 offen offset:448 nt
    s_add_u32 s10, s80, 1048576
    buffer_load_dwordx4 a[128:131], v4, s[40:43], s10 offen offset:0 nt
    s_add_u32 s10, s80, 1048576
    buffer_load_dwordx4 a[132:135], v4, s[40:43], s10 offen offset:64 nt
    s_cmp_lg_u32 s7, 0
    s_cbranch_scc1 Lwk10
    buffer_load_dword v7, v6, s[76:79], 0 offen sc1
Lwk10:
    s_add_u32 s10, s80, 1048576
    buffer_load_dwordx4 a[136:139], v4, s[40:43], s10 offen offset:128 nt
    s_add_u32 s10, s80, 1048576
    buffer_load_dwordx4 a[140:143], v4, s[40:43], s10 offen offset:192 nt
    s_add_u32 s10, s80, 1048576
    buffer_load_dwordx4 a[144:147], v4, s[40:43], s10 offen offset:256 nt
    s_add_u32 s10, s80, 1048576
    buffer_load_dwordx4 a[148:151], v4, s[40:43], s10 offen offset:320 nt
    s_add_u32 s10, s80, 1048576
    buffer_load_dwordx4 a[152:155], v4, s[40:43], s10 offen offset:384 nt
    s_add_u32 s10, s80, 1048576
    buffer_load_dwordx4 a[156:159], v4, s[40:43], s10 offen offset:448 nt
    s_add_u32 s10, s80, 1310720
    buffer_load_dwordx4 a[160:163], v4, s[40:43], s10 offen offset:0 nt
    s_add_u32 s10, s80, 1310720
    buffer_load_dwordx4 a[164:167], v4, s[40:43], s10 offen offset:64 nt
    s_add_u32 s10, s80, 1310720
    buffer_load_dwordx4 a[168:171], v4, s[40:43], s10 offen offset:128 nt
    s_add_u32 s10, s80, 1310720
    buffer_load_dwordx4 a[172:175], v4, s[40:43], s10 offen offset:192 nt
    s_add_u32 s10, s80, 1310720
    buffer_load_dwordx4 a[176:179], v4, s[40:43], s10 offen offset:256 nt
    s_add_u32 s10, s80, 1310720
    buffer_load_dwordx4 a[180:183], v4, s[40:43], s10 offen offset:320 nt
    s_add_u32 s10, s80, 1310720
    buffer_load_dwordx4 a[184:187], v4, s[40:43], s10 offen offset:384 nt
    s_add_u32 s10, s80, 1310720
    buffer_load_dwordx4 a[188:191], v4, s[40:43], s10 offen offset:448 nt
    s_add_u32 s10, s80, 1572864
    buffer_load_dwordx4 a[192:195], v4, s[40:43], s10 offen offset:0 nt
    s_add_u32 s10, s80, 1572864
    buffer_load_dwordx4 a[196:199], v4, s[40:43], s10 offen offset:64 nt
    s_add_u32 s10, s80, 1572864
    buffer_load_dwordx4 a[200:203], v4, s[40:43], s10 offen offset:128 nt
    s_add_u32 s10, s80, 1572864
    buffer_load_dwordx4 a[204:207], v4, s[40:43], s10 offen offset:192 nt
    s_cmp_lg_u32 s7, 0
    s_cbranch_scc1 Lwk11
    s_waitcnt vmcnt(18)
    s_mov_b32 s98, 0
Lcnt:
    v_cmp_gt_u32 vcc, 8, v7
    s_cbranch_vccz Lcntd
    buffer_load_dword v7, v6, s[76:79], 0 offen sc1
    s_waitcnt vmcnt(0)
    s_add_u32 s98, s98, 1
    s_cmp_lt_u32 s98, 0x8000
    s_cbranch_scc1 Lcnt
Lcntd:
    buffer_load_dwordx4 v[16:19], v1, s[64:67], s90 offen sc1
Lwk11:
    s_add_u32 s10, s80, 1572864
    buffer_load_dwordx4 a[208:211], v4, s[40:43], s10 offen offset:256 nt
    s_add_u32 s10, s80, 1572864
    buffer_load_dwordx4 a[212:215], v4, s[40:43], s10 offen offset:320 nt
    s_add_u32 s10, s80, 1572864
    buffer_load_dwordx4 a[216:219], v4, s[40:43], s10 offen offset:384 nt
    s_add_u32 s10, s80, 1572864
    buffer_load_dwordx4 a[220:223], v4, s[40:43], s10 offen offset:448 nt
    s_add_u32 s10, s80, 1835008
    buffer_load_dwordx4 a[224:227], v4, s[40:43], s10 offen offset:0 nt
    s_add_u32 s10, s80, 1835008
    buffer_load_dwordx4 a[228:231], v4, s[40:43], s10 offen offset:64 nt
    s_add_u32 s10, s80, 1835008
    buffer_load_dwordx4 a[232:235], v4, s[40:43], s10 offen offset:128 nt
    s_add_u32 s10, s80, 1835008
    buffer_load_dwordx4 a[236:239], v4, s[40:43], s10 offen offset:192 nt
    s_add_u32 s10, s80, 1835008
    buffer_load_dwordx4 a[240:243], v4, s[40:43], s10 offen offset:256 nt
    s_add_u32 s10, s80, 1835008
    buffer_load_dwordx4 a[244:247], v4, s[40:43], s10 offen offset:320 nt
    s_add_u32 s10, s80, 1835008
    buffer_load_dwordx4 a[248:251], v4, s[40:43], s10 offen offset:384 nt
    s_add_u32 s10, s80, 1835008
    buffer_load_dwordx4 a[252:255], v4, s[40:43], s10 offen offset:448 nt
    s_add_u32 s10, s80, 0
    s_add_u32 m0, s81, 4096
    s_nop 0
    buffer_load_dwordx4 v5, s[44:47], s10 offen offset:0 nt lds
    s_add_u32 s10, s80, 0
    s_add_u32 m0, s81, 4864
    s_nop 0
    buffer_load_dwordx4 v5, s[44:47], s10 offen offset:256 nt lds
    s_add_u32 s10, s80, 0
    s_add_u32 m0, s81, 5632
    s_nop 0
    buffer_load_dwordx4 v5, s[44:47], s10 offen offset:512 nt lds
    s_add_u32 s10, s80, 0
    s_add_u32 m0, s81, 6400
    s_nop 0
    buffer_load_dwordx4 v5, s[44:47], s10 offen offset:768 nt lds
    s_add_u32 s10, s80, 0
    s_add_u32 m0, s81, 7168
    s_nop 0
    buffer_load_dwordx4 v5, s[44:47], s10 offen offset:1024 nt lds
    s_add_u32 s10, s80, 0
    s_add_u32 m0, s81, 7936
    s_nop 0
    buffer_load_dwordx4 v5, s[44:47], s10 offen offset:1280 nt lds
    s_cmp_lg_u32 s7, 0
    s_cbranch_scc1 Lwk12
    s_waitcnt vmcnt(18)
    v_max3_u32 v15, v16, v17, v18
    v_max_u32 v15, v15, v19
    v_cmp_eq_u32 vcc, -1, v15
    s_cbranch_vccz Lattn
    s_mov_b32 s98, 0
Lpoll13:
    buffer_load_dwordx4 v[16:19], v1, s[64:67], s90 offen sc1
    s_waitcnt vmcnt(0)
    v_max3_u32 v15, v16, v17, v18
    v_max_u32 v15, v15, v19
    v_cmp_eq_u32 vcc, -1, v15
    s_cbranch_vccz Lpoll13d
    s_add_u32 s98, s98, 1
    s_cmp_lt_u32 s98, 0x8000
    s_cbranch_scc1 Lpoll13
Lpoll13d:
Lattn:
    ds_write_b128 v1, v[16:19] offset:8192
    v_mov_b32 v6, 0
    v_mov_b32 v7, 1
    s_waitcnt lgkmcnt(0)
    ds_write_b32 v6, v7 offset:16256
Lwk12:
    s_add_u32 s10, s80, 0
    s_add_u32 m0, s81, 8704
    s_nop 0
    buffer_load_dwordx4 v5, s[44:47], s10 offen offset:1536 nt lds
    s_add_u32 s10, s80, 0
    s_add_u32 m0, s81, 9472
    s_nop 0
    buffer_load_dwordx4 v5, s[44:47], s10 offen offset:1792 nt lds
    s_add_u32 s10, s80, 262144
    s_add_u32 m0, s81, 12288
    s_nop 0
    buffer_load_dwordx4 v5, s[44:47], s10 offen offset:0 nt lds
    s_add_u32 s10, s80, 262144
    buffer_load_dwordx4 v[144:147], v5, s[44:47], s10 offen offset:256 nt
    s_add_u32 s10, s80, 262144
    s_add_u32 m0, s81, 12800
    s_nop 0
    buffer_load_dwordx4 v5, s[44:47], s10 offen offset:512 nt lds
    s_add_u32 s10, s80, 262144
    buffer_load_dwordx4 v[148:151], v5, s[44:47], s10 offen offset:768 nt
    s_add_u32 s10, s80, 262144
    s_add_u32 m0, s81, 13312
    s_nop 0
    buffer_load_dwordx4 v5, s[44:47], s10 offen offset:1024 nt lds
    s_add_u32 s10, s80, 262144
    buffer_load_dwordx4 v[152:155], v5, s[44:47], s10 offen offset:1280 nt
    s_add_u32 s10, s80, 262144
    s_add_u32 m0, s81, 13824
    s_nop 0
    buffer_load_dwordx4 v5, s[44:47], s10 offen offset:1536 nt lds
    s_add_u32 s10, s80, 262144
    buffer_load_dwordx4 v[156:159], v5, s[44:47], s10 offen offset:1792 nt
    v_mov_b32 v6, 0
    s_mov_b32 s98, 0
Lqf:
    ds_read_b32 v7, v6 offset:16256
    s_waitcnt lgkmcnt(0)
    v_cmp_eq_u32 vcc, 0, v7
    s_cbranch_vccz Lqfd
    s_sleep 2
    s_add_u32 s98, s98, 1
    s_cmp_lt_u32 s98, 0x400000
    s_cbranch_scc1 Lqf
Lqfd:
    ds_read_b128 v[16:19], v2 offset:8192
    ds_read_b128 v[20:23], v2 offset:8256
    ds_read_b128 v[24:27], v2 offset:8320
    ds_read_b128 v[28:31], v2 offset:8384
    ds_read_b128 v[64:67], v2 offset:8448
    ds_read_b128 v[68:71], v2 offset:8512
    ds_read_b128 v[72:75], v2 offset:8576
    ds_read_b128 v[76:79], v2 offset:8640
    s_add_u32 s10, s80, 524288
    s_add_u32 m0, s81, 16384
    s_nop 0
    buffer_load_dwordx4 v5, s[44:47], s10 offen offset:0 nt lds
    s_add_u32 s10, s80, 524288
    buffer_load_dwordx4 v[160:163], v5, s[44:47], s10 offen offset:256 nt
    s_add_u32 s10, s80, 524288
    s_add_u32 m0, s81, 16896
    s_nop 0
    buffer_load_dwordx4 v5, s[44:47], s10 offen offset:512 nt lds
    s_add_u32 s10, s80, 524288
    buffer_load_dwordx4 v[164:167], v5, s[44:47], s10 offen offset:768 nt
    s_waitcnt vmcnt(63)
    s_waitcnt lgkmcnt(7)
    v_mfma_f32_16x16x32_bf16 v[32:35], a[0:3], v[16:19], 0
    v_lshrrev_b32 v6, 2, v8
    v_mfma_f32_16x16x32_bf16 v[36:39], a[32:35], v[16:19], 0
    v_bfi_b32 v6, v6, 0, s91
    s_waitcnt lgkmcnt(6)
    v_mfma_f32_16x16x32_bf16 v[32:35], a[4:7], v[20:23], v[32:35]
    v_or_b32 v1, v6, v8
    v_mfma_f32_16x16x32_bf16 v[36:39], a[36:39], v[20:23], v[36:39]
    v_lshrrev_b32 v6, 2, v9
    s_waitcnt lgkmcnt(5)
    v_mfma_f32_16x16x32_bf16 v[32:35], a[8:11], v[24:27], v[32:35]
    v_bfi_b32 v6, v6, 0, s91
    v_mfma_f32_16x16x32_bf16 v[36:39], a[40:43], v[24:27], v[36:39]
    v_or_b32 v2, v6, v9
    s_waitcnt lgkmcnt(4)
    v_mfma_f32_16x16x32_bf16 v[32:35], a[12:15], v[28:31], v[32:35]
    v_lshrrev_b32 v6, 2, v10
    v_mfma_f32_16x16x32_bf16 v[36:39], a[44:47], v[28:31], v[36:39]
    v_bfi_b32 v6, v6, 0, s91
    s_waitcnt lgkmcnt(3)
    v_mfma_f32_16x16x32_bf16 v[32:35], a[16:19], v[64:67], v[32:35]
    v_or_b32 v13, v6, v10
    v_mfma_f32_16x16x32_bf16 v[36:39], a[48:51], v[64:67], v[36:39]
    v_lshrrev_b32 v6, 2, v11
    s_waitcnt lgkmcnt(2)
    v_mfma_f32_16x16x32_bf16 v[32:35], a[20:23], v[68:71], v[32:35]
    v_bfi_b32 v6, v6, 0, s91
    v_or_b32 v15, v6, v11
    v_mfma_f32_16x16x32_bf16 v[36:39], a[52:55], v[68:71], v[36:39]
    s_waitcnt lgkmcnt(1)
    v_mfma_f32_16x16x32_bf16 v[32:35], a[24:27], v[72:75], v[32:35]
    v_mfma_f32_16x16x32_bf16 v[36:39], a[56:59], v[72:75], v[36:39]
    s_waitcnt lgkmcnt(0)
    v_mfma_f32_16x16x32_bf16 v[32:35], a[28:31], v[76:79], v[32:35]
    v_mfma_f32_16x16x32_bf16 v[36:39], a[60:63], v[76:79], v[36:39]
    s_add_u32 s10, s80, 524288
    s_add_u32 m0, s81, 17408
    s_nop 0
    buffer_load_dwordx4 v5, s[44:47], s10 offen offset:1024 nt lds
    s_add_u32 s10, s80, 524288
    buffer_load_dwordx4 v[168:171], v5, s[44:47], s10 offen offset:1280 nt
    s_add_u32 s10, s80, 524288
    s_add_u32 m0, s81, 17920
    s_nop 0
    buffer_load_dwordx4 v5, s[44:47], s10 offen offset:1536 nt lds
    s_add_u32 s10, s80, 524288
    buffer_load_dwordx4 v[172:175], v5, s[44:47], s10 offen offset:1792 nt
    s_waitcnt vmcnt(56)
    v_mfma_f32_16x16x32_bf16 v[40:43], a[64:67], v[16:19], 0
    v_mfma_f32_16x16x32_bf16 v[44:47], a[96:99], v[16:19], 0
    v_mfma_f32_16x16x32_bf16 v[40:43], a[68:71], v[20:23], v[40:43]
    v_mfma_f32_16x16x32_bf16 v[44:47], a[100:103], v[20:23], v[44:47]
    v_cvt_pk_bf16_f32 v6, v32, v33
    v_mfma_f32_16x16x32_bf16 v[40:43], a[72:75], v[24:27], v[40:43]
    v_cvt_pk_bf16_f32 v7, v34, v35
    v_mfma_f32_16x16x32_bf16 v[44:47], a[104:107], v[24:27], v[44:47]
    v_lshlrev_b32 v32, 16, v6
    v_mfma_f32_16x16x32_bf16 v[40:43], a[76:79], v[28:31], v[40:43]
    v_and_b32 v33, 0xffff0000, v6
    v_mfma_f32_16x16x32_bf16 v[44:47], a[108:111], v[28:31], v[44:47]
    v_lshlrev_b32 v34, 16, v7
    v_mfma_f32_16x16x32_bf16 v[40:43], a[80:83], v[64:67], v[40:43]
    v_and_b32 v35, 0xffff0000, v7
    v_mfma_f32_16x16x32_bf16 v[44:47], a[112:115], v[64:67], v[44:47]
    v_max_f32 v12, v32, v33
    v_mfma_f32_16x16x32_bf16 v[40:43], a[84:87], v[68:71], v[40:43]
    v_max3_f32 v12, v12, v34, v35
    v_cvt_pk_bf16_f32 v6, v36, v37
    v_mfma_f32_16x16x32_bf16 v[44:47], a[116:119], v[68:71], v[44:47]
    v_cvt_pk_bf16_f32 v7, v38, v39
    v_lshlrev_b32 v36, 16, v6
    v_mfma_f32_16x16x32_bf16 v[40:43], a[88:91], v[72:75], v[40:43]
    v_and_b32 v37, 0xffff0000, v6
    v_lshlrev_b32 v38, 16, v7
    v_mfma_f32_16x16x32_bf16 v[44:47], a[120:123], v[72:75], v[44:47]
    v_and_b32 v39, 0xffff0000, v7
    v_max3_f32 v12, v12, v36, v37
    v_mfma_f32_16x16x32_bf16 v[40:43], a[92:95], v[76:79], v[40:43]
    v_max3_f32 v12, v12, v38, v39
    v_mfma_f32_16x16x32_bf16 v[44:47], a[124:127], v[76:79], v[44:47]
    s_add_u32 s10, s80, 786432
    s_add_u32 m0, s81, 20480
    s_nop 0
    buffer_load_dwordx4 v5, s[44:47], s10 offen offset:0 nt lds
    s_add_u32 s10, s80, 786432
    buffer_load_dwordx4 v[176:179], v5, s[44:47], s10 offen offset:256 nt
    s_add_u32 s10, s80, 786432
    s_add_u32 m0, s81, 20992
    s_nop 0
    buffer_load_dwordx4 v5, s[44:47], s10 offen offset:512 nt lds
    s_add_u32 s10, s80, 786432
    buffer_load_dwordx4 v[180:183], v5, s[44:47], s10 offen offset:768 nt
    s_waitcnt vmcnt(44)
    v_mfma_f32_16x16x32_bf16 v[48:51], a[128:131], v[16:19], 0
    v_mfma_f32_16x16x32_bf16 v[52:55], a[160:163], v[16:19], 0
    v_mfma_f32_16x16x32_bf16 v[48:51], a[132:135], v[20:23], v[48:51]
    v_mfma_f32_16x16x32_bf16 v[52:55], a[164:167], v[20:23], v[52:55]
    v_cvt_pk_bf16_f32 v6, v40, v41
    v_mfma_f32_16x16x32_bf16 v[48:51], a[136:139], v[24:27], v[48:51]
    v_cvt_pk_bf16_f32 v7, v42, v43
    v_mfma_f32_16x16x32_bf16 v[52:55], a[168:171], v[24:27], v[52:55]
    v_lshlrev_b32 v40, 16, v6
    v_mfma_f32_16x16x32_bf16 v[48:51], a[140:143], v[28:31], v[48:51]
    v_and_b32 v41, 0xffff0000, v6
    v_mfma_f32_16x16x32_bf16 v[52:55], a[172:175], v[28:31], v[52:55]
    v_lshlrev_b32 v42, 16, v7
    v_mfma_f32_16x16x32_bf16 v[48:51], a[144:147], v[64:67], v[48:51]
    v_and_b32 v43, 0xffff0000, v7
    v_mfma_f32_16x16x32_bf16 v[52:55], a[176:179], v[64:67], v[52:55]
    v_max3_f32 v12, v12, v40, v41
    v_mfma_f32_16x16x32_bf16 v[48:51], a[148:151], v[68:71], v[48:51]
    v_max3_f32 v12, v12, v42, v43
    v_cvt_pk_bf16_f32 v6, v44, v45
    v_mfma_f32_16x16x32_bf16 v[52:55], a[180:183], v[68:71], v[52:55]
    v_cvt_pk_bf16_f32 v7, v46, v47
    v_lshlrev_b32 v44, 16, v6
    v_mfma_f32_16x16x32_bf16 v[48:51], a[152:155], v[72:75], v[48:51]
    v_and_b32 v45, 0xffff0000, v6
    v_lshlrev_b32 v46, 16, v7
    v_mfma_f32_16x16x32_bf16 v[52:55], a[184:187], v[72:75], v[52:55]
    v_and_b32 v47, 0xffff0000, v7
    v_max3_f32 v12, v12, v44, v45
    v_mfma_f32_16x16x32_bf16 v[48:51], a[156:159], v[76:79], v[48:51]
    v_max3_f32 v12, v12, v46, v47
    v_mfma_f32_16x16x32_bf16 v[52:55], a[188:191], v[76:79], v[52:55]
    s_add_u32 s10, s80, 786432
    s_add_u32 m0, s81, 21504
    s_nop 0
    buffer_load_dwordx4 v5, s[44:47], s10 offen offset:1024 nt lds
    s_add_u32 s10, s80, 786432
    buffer_load_dwordx4 v[184:187], v5, s[44:47], s10 offen offset:1280 nt
    s_add_u32 s10, s80, 786432
    s_add_u32 m0, s81, 22016
    s_nop 0
    buffer_load_dwordx4 v5, s[44:47], s10 offen offset:1536 nt lds
    s_add_u32 s10, s80, 786432
    buffer_load_dwordx4 v[188:191], v5, s[44:47], s10 offen offset:1792 nt
    s_waitcnt vmcnt(32)
    v_mfma_f32_16x16x32_bf16 v[56:59], a[192:195], v[16:19], 0
    v_mfma_f32_16x16x32_bf16 v[60:63], a[224:227], v[16:19], 0
    v_mfma_f32_16x16x32_bf16 v[56:59], a[196:199], v[20:23], v[56:59]
    v_mfma_f32_16x16x32_bf16 v[60:63], a[228:231], v[20:23], v[60:63]
    v_cvt_pk_bf16_f32 v6, v48, v49
    v_mfma_f32_16x16x32_bf16 v[56:59], a[200:203], v[24:27], v[56:59]
    v_cvt_pk_bf16_f32 v7, v50, v51
    v_mfma_f32_16x16x32_bf16 v[60:63], a[232:235], v[24:27], v[60:63]
    v_lshlrev_b32 v48, 16, v6
    v_mfma_f32_16x16x32_bf16 v[56:59], a[204:207], v[28:31], v[56:59]
    v_and_b32 v49, 0xffff0000, v6
    v_mfma_f32_16x16x32_bf16 v[60:63], a[236:239], v[28:31], v[60:63]
    v_lshlrev_b32 v50, 16, v7
    v_mfma_f32_16x16x32_bf16 v[56:59], a[208:211], v[64:67], v[56:59]
    v_and_b32 v51, 0xffff0000, v7
    v_mfma_f32_16x16x32_bf16 v[60:63], a[240:243], v[64:67], v[60:63]
    v_max3_f32 v12, v12, v48, v49
    v_mfma_f32_16x16x32_bf16 v[56:59], a[212:215], v[68:71], v[56:59]
    v_max3_f32 v12, v12, v50, v51
    v_cvt_pk_bf16_f32 v6, v52, v53
    v_mfma_f32_16x16x32_bf16 v[60:63], a[244:247], v[68:71], v[60:63]
    v_cvt_pk_bf16_f32 v7, v54, v55
    v_lshlrev_b32 v52, 16, v6
    v_mfma_f32_16x16x32_bf16 v[56:59], a[216:219], v[72:75], v[56:59]
    v_and_b32 v53, 0xffff0000, v6
    v_lshlrev_b32 v54, 16, v7
    v_mfma_f32_16x16x32_bf16 v[60:63], a[248:251], v[72:75], v[60:63]
    v_and_b32 v55, 0xffff0000, v7
    v_max3_f32 v12, v12, v52, v53
    v_mfma_f32_16x16x32_bf16 v[56:59], a[220:223], v[76:79], v[56:59]
    v_max3_f32 v12, v12, v54, v55
    v_mfma_f32_16x16x32_bf16 v[60:63], a[252:255], v[76:79], v[60:63]
    s_waitcnt vmcnt(31)
    ds_read_b128 v[64:67], v3 offset:4096
    s_waitcnt vmcnt(30)
    ds_read_b128 v[68:71], v3 offset:5120
    s_waitcnt vmcnt(29)
    ds_read_b128 v[72:75], v3 offset:6144
    s_waitcnt vmcnt(28)
    ds_read_b128 v[76:79], v3 offset:7168
    s_nop 3
    v_cvt_pk_bf16_f32 v6, v56, v57
    v_cvt_pk_bf16_f32 v7, v58, v59
    v_lshlrev_b32 v56, 16, v6
    v_and_b32 v57, 0xffff0000, v6
    v_lshlrev_b32 v58, 16, v7
    v_and_b32 v59, 0xffff0000, v7
    v_max3_f32 v12, v12, v56, v57
    v_max3_f32 v12, v12, v58, v59
    v_cvt_pk_bf16_f32 v6, v60, v61
    v_cvt_pk_bf16_f32 v7, v62, v63
    v_lshlrev_b32 v60, 16, v6
    v_and_b32 v61, 0xffff0000, v6
    v_lshlrev_b32 v62, 16, v7
    v_and_b32 v63, 0xffff0000, v7
    v_max3_f32 v12, v12, v60, v61
    v_max3_f32 v12, v12, v62, v63
    v_mov_b32 v6, v12
    s_nop 1
    v_permlane16_swap_b32 v12, v6
    s_nop 1
    v_max_f32 v12, v12, v6
    v_mov_b32 v6, v12
    s_nop 1
    v_permlane32_swap_b32 v12, v6
    v_mov_b32 v7, 0
    s_nop 0
    v_max_f32 v12, v12, v6
    v_mul_f32 v14, s99, v12
    v_mov_b32 v6, 0
    v_pk_fma_f32 v[32:33], v[32:33], s[98:99], v[14:15] op_sel:[0,1,0] op_sel_hi:[1,1,0] neg_lo:[0,0,1] neg_hi:[0,0,1]
    v_pk_fma_f32 v[34:35], v[34:35], s[98:99], v[14:15] op_sel:[0,1,0] op_sel_hi:[1,1,0] neg_lo:[0,0,1] neg_hi:[0,0,1]
    v_exp_f32 v32, v32
    v_exp_f32 v33, v33
    v_exp_f32 v34, v34
    v_exp_f32 v35, v35
    v_pk_add_f32 v[6:7], v[6:7], v[32:33]
    v_cvt_pk_bf16_f32 v32, v32, v33
    v_cvt_pk_bf16_f32 v33, v34, v35
    v_pk_add_f32 v[6:7], v[6:7], v[34:35]
    v_perm_b32 v16, v32, v32, v8
    v_perm_b32 v17, v32, v32, v9
    v_perm_b32 v18, v32, v32, v10
    v_perm_b32 v19, v32, v32, v11
    s_nop 0
    s_add_u32 s10, s80, 1048576
    s_add_u32 m0, s81, 24576
    s_nop 0
    buffer_load_dwordx4 v5, s[44:47], s10 offen offset:0 nt lds
    s_add_u32 s10, s80, 1048576
    buffer_load_dwordx4 v[192:195], v5, s[44:47], s10 offen offset:256 nt
    s_waitcnt lgkmcnt(3)
    v_mfma_f32_16x16x32_bf16 v[24:27], v[64:67], v[16:19], 0
    s_waitcnt vmcnt(29)
    ds_read_b128 v[64:67], v3 offset:8192
    v_perm_b32 v20, v32, v32, v1
    v_perm_b32 v21, v32, v32, v2
    v_perm_b32 v22, v32, v32, v13
    v_perm_b32 v23, v32, v32, v15
    s_waitcnt lgkmcnt(3)
    v_mfma_f32_16x16x32_bf16 v[28:31], v[68:71], v[16:19], 0
    s_waitcnt vmcnt(28)
    ds_read_b128 v[68:71], v3 offset:9216
    v_pk_fma_f32 v[36:37], v[36:37], s[98:99], v[14:15] op_sel:[0,1,0] op_sel_hi:[1,1,0] neg_lo:[0,0,1] neg_hi:[0,0,1]
    v_pk_fma_f32 v[38:39], v[38:39], s[98:99], v[14:15] op_sel:[0,1,0] op_sel_hi:[1,1,0] neg_lo:[0,0,1] neg_hi:[0,0,1]
    v_exp_f32 v36, v36
    v_exp_f32 v37, v37
    s_add_u32 s10, s80, 1048576
    s_add_u32 m0, s81, 25088
    s_nop 0
    buffer_load_dwordx4 v5, s[44:47], s10 offen offset:512 nt lds
    s_add_u32 s10, s80, 1048576
    buffer_load_dwordx4 v[196:199], v5, s[44:47], s10 offen offset:768 nt
    s_waitcnt lgkmcnt(3)
    v_mfma_f32_16x16x32_bf16 v[24:27], v[72:75], v[20:23], v[24:27]
    s_waitcnt vmcnt(29)
    ds_read_b128 v[72:75], v3 offset:10240
    v_perm_b32 v16, v33, v33, v8
    v_perm_b32 v17, v33, v33, v9
    v_perm_b32 v18, v33, v33, v10
    v_perm_b32 v19, v33, v33, v11
    s_waitcnt lgkmcnt(3)
    v_mfma_f32_16x16x32_bf16 v[28:31], v[76:79], v[20:23], v[28:31]
    s_waitcnt vmcnt(28)
    ds_read_b128 v[76:79], v3 offset:11264
    v_exp_f32 v38, v38
    v_exp_f32 v39, v39
    v_pk_add_f32 v[6:7], v[6:7], v[36:37]
    v_cvt_pk_bf16_f32 v36, v36, v37
    s_add_u32 s10, s80, 1048576
    s_add_u32 m0, s81, 25600
    s_nop 0
    buffer_load_dwordx4 v5, s[44:47], s10 offen offset:1024 nt lds
    s_add_u32 s10, s80, 1048576
    buffer_load_dwordx4 v[200:203], v5, s[44:47], s10 offen offset:1280 nt
    s_waitcnt lgkmcnt(3)
    v_mfma_f32_16x16x32_bf16 v[24:27], v[64:67], v[16:19], v[24:27]
    s_waitcnt vmcnt(29)
    ds_read_b128 v[64:67], v3 offset:12288
    v_perm_b32 v20, v33, v33, v1
    v_perm_b32 v21, v33, v33, v2
    v_perm_b32 v22, v33, v33, v13
    v_perm_b32 v23, v33, v33, v15
    s_waitcnt lgkmcnt(3)
    v_mfma_f32_16x16x32_bf16 v[28:31], v[68:71], v[16:19], v[28:31]
    s_waitcnt vmcnt(27)
    ds_read_b128 v[68:71], v3 offset:13312
    v_cvt_pk_bf16_f32 v37, v38, v39
    s_add_u32 s10, s80, 1048576
    s_add_u32 m0, s81, 26112
    s_nop 0
    buffer_load_dwordx4 v5, s[44:47], s10 offen offset:1536 nt lds
    s_add_u32 s10, s80, 1048576
    buffer_load_dwordx4 v[204:207], v5, s[44:47], s10 offen offset:1792 nt
    s_waitcnt lgkmcnt(3)
    v_mfma_f32_16x16x32_bf16 v[24:27], v[72:75], v[20:23], v[24:27]
    s_waitcnt vmcnt(27)
    ds_read_b128 v[72:75], v3 offset:14336
    v_perm_b32 v16, v36, v36, v8
    v_perm_b32 v17, v36, v36, v9
    v_perm_b32 v18, v36, v36, v10
    v_perm_b32 v19, v36, v36, v11
    s_waitcnt lgkmcnt(3)
    v_mfma_f32_16x16x32_bf16 v[28:31], v[76:79], v[20:23], v[28:31]
    s_waitcnt vmcnt(25)
    ds_read_b128 v[76:79], v3 offset:15360
    v_pk_add_f32 v[6:7], v[6:7], v[38:39]
    s_add_u32 s10, s80, 1310720
    s_add_u32 m0, s81, 28672
    s_nop 0
    buffer_load_dwordx4 v5, s[44:47], s10 offen offset:0 nt lds
    s_add_u32 s10, s80, 1310720
    buffer_load_dwordx4 v[208:211], v5, s[44:47], s10 offen offset:256 nt
    s_waitcnt lgkmcnt(3)
    v_mfma_f32_16x16x32_bf16 v[24:27], v[64:67], v[16:19], v[24:27]
    s_waitcnt vmcnt(25)
    ds_read_b128 v[64:67], v3 offset:16384
    v_perm_b32 v20, v36, v36, v1
    v_perm_b32 v21, v36, v36, v2
    v_perm_b32 v22, v36, v36, v13
    v_perm_b32 v23, v36, v36, v15
    s_waitcnt vmcnt(32)
    v_mfma_f32_16x16x32_bf16 v[28:31], v[144:147], v[16:19], v[28:31]
    v_pk_fma_f32 v[40:41], v[40:41], s[98:99], v[14:15] op_sel:[0,1,0] op_sel_hi:[1,1,0] neg_lo:[0,0,1] neg_hi:[0,0,1]
    v_pk_fma_f32 v[42:43], v[42:43], s[98:99], v[14:15] op_sel:[0,1,0] op_sel_hi:[1,1,0] neg_lo:[0,0,1] neg_hi:[0,0,1]
    v_exp_f32 v40, v40
    v_exp_f32 v41, v41
    s_add_u32 s10, s80, 1310720
    s_add_u32 m0, s81, 29184
    s_nop 0
    buffer_load_dwordx4 v5, s[44:47], s10 offen offset:512 nt lds
    s_add_u32 s10, s80, 1310720
    buffer_load_dwordx4 v[212:215], v5, s[44:47], s10 offen offset:768 nt
    s_waitcnt lgkmcnt(3)
    v_mfma_f32_16x16x32_bf16 v[24:27], v[68:71], v[20:23], v[24:27]
    s_waitcnt vmcnt(25)
    ds_read_b128 v[68:71], v3 offset:17408
    v_perm_b32 v16, v37, v37, v8
    v_perm_b32 v17, v37, v37, v9
    v_perm_b32 v18, v37, v37, v10
    v_perm_b32 v19, v37, v37, v11
    s_waitcnt vmcnt(32)
    v_mfma_f32_16x16x32_bf16 v[28:31], v[148:151], v[20:23], v[28:31]
    v_exp_f32 v42, v42
    v_exp_f32 v43, v43
    v_pk_add_f32 v[6:7], v[6:7], v[40:41]
    v_cvt_pk_bf16_f32 v40, v40, v41
    s_add_u32 s10, s80, 1310720
    s_add_u32 m0, s81, 29696
    s_nop 0
    buffer_load_dwordx4 v5, s[44:47], s10 offen offset:1024 nt lds
    s_add_u32 s10, s80, 1310720
    buffer_load_dwordx4 v[216:219], v5, s[44:47], s10 offen offset:1280 nt
    s_waitcnt lgkmcnt(3)
    v_mfma_f32_16x16x32_bf16 v[24:27], v[72:75], v[16:19], v[24:27]
    s_waitcnt vmcnt(25)
    ds_read_b128 v[72:75], v3 offset:18432
    v_perm_b32 v20, v37, v37, v1
    v_perm_b32 v21, v37, v37, v2
    v_perm_b32 v22, v37, v37, v13
    v_perm_b32 v23, v37, v37, v15
    s_waitcnt vmcnt(32)
    v_mfma_f32_16x16x32_bf16 v[28:31], v[152:155], v[16:19], v[28:31]
    v_cvt_pk_bf16_f32 v41, v42, v43
    s_add_u32 s10, s80, 1310720
    s_add_u32 m0, s81, 30208
    s_nop 0
    buffer_load_dwordx4 v5, s[44:47], s10 offen offset:1536 nt lds
    s_add_u32 s10, s80, 1310720
    buffer_load_dwordx4 v[220:223], v5, s[44:47], s10 offen offset:1792 nt
    s_waitcnt lgkmcnt(3)
    v_mfma_f32_16x16x32_bf16 v[24:27], v[76:79], v[20:23], v[24:27]
    s_waitcnt vmcnt(25)
    ds_read_b128 v[76:79], v3 offset:19456
    v_perm_b32 v16, v40, v40, v8
    v_perm_b32 v17, v40, v40, v9
    v_perm_b32 v18, v40, v40, v10
    v_perm_b32 v19, v40, v40, v11
    s_waitcnt vmcnt(32)
    v_mfma_f32_16x16x32_bf16 v[28:31], v[156:159], v[20:23], v[28:31]
    v_pk_add_f32 v[6:7], v[6:7], v[42:43]
    s_add_u32 s10, s80, 1572864
    s_add_u32 m0, s81, 32768
    s_nop 0
    buffer_load_dwordx4 v5, s[44:47], s10 offen offset:0 nt lds
    s_add_u32 s10, s80, 1572864
    buffer_load_dwordx4 v[224:227], v5, s[44:47], s10 offen offset:256 nt
    s_cmp_lg_u32 s7, 0
    s_cbranch_scc1 Lwk14
    v_and_b32 v4, 15, v0
    v_lshlrev_b32 v4, 4, v4
    buffer_load_dword v4, v4, s[76:79], 0 offen sc1
Lwk14:
    s_waitcnt lgkmcnt(3)
    v_mfma_f32_16x16x32_bf16 v[24:27], v[64:67], v[16:19], v[24:27]
    s_waitcnt vmcnt(25)
    ds_read_b128 v[64:67], v3 offset:20480
    v_perm_b32 v20, v40, v40, v1
    v_perm_b32 v21, v40, v40, v2
    v_perm_b32 v22, v40, v40, v13
    v_perm_b32 v23, v40, v40, v15
    s_waitcnt vmcnt(32)
    v_mfma_f32_16x16x32_bf16 v[28:31], v[160:163], v[16:19], v[28:31]
    v_pk_fma_f32 v[44:45], v[44:45], s[98:99], v[14:15] op_sel:[0,1,0] op_sel_hi:[1,1,0] neg_lo:[0,0,1] neg_hi:[0,0,1]
    v_pk_fma_f32 v[46:47], v[46:47], s[98:99], v[14:15] op_sel:[0,1,0] op_sel_hi:[1,1,0] neg_lo:[0,0,1] neg_hi:[0,0,1]
    v_exp_f32 v44, v44
    v_exp_f32 v45, v45
    s_add_u32 s10, s80, 1572864
    s_add_u32 m0, s81, 33280
    s_nop 0
    buffer_load_dwordx4 v5, s[44:47], s10 offen offset:512 nt lds
    s_add_u32 s10, s80, 1572864
    buffer_load_dwordx4 v[228:231], v5, s[44:47], s10 offen offset:768 nt
    s_waitcnt lgkmcnt(3)
    v_mfma_f32_16x16x32_bf16 v[24:27], v[68:71], v[20:23], v[24:27]
    s_waitcnt vmcnt(25)
    ds_read_b128 v[68:71], v3 offset:21504
    v_perm_b32 v16, v41, v41, v8
    v_perm_b32 v17, v41, v41, v9
    v_perm_b32 v18, v41, v41, v10
    v_perm_b32 v19, v41, v41, v11
    s_waitcnt vmcnt(32)
    v_mfma_f32_16x16x32_bf16 v[28:31], v[164:167], v[20:23], v[28:31]
    v_exp_f32 v46, v46
    v_exp_f32 v47, v47
    v_pk_add_f32 v[6:7], v[6:7], v[44:45]
    v_cvt_pk_bf16_f32 v44, v44, v45
    s_add_u32 s10, s80, 1572864
    s_add_u32 m0, s81, 33792
    s_nop 0
    buffer_load_dwordx4 v5, s[44:47], s10 offen offset:1024 nt lds
    s_add_u32 s10, s80, 1572864
    buffer_load_dwordx4 v[232:235], v5, s[44:47], s10 offen offset:1280 nt
    s_waitcnt lgkmcnt(3)
    v_mfma_f32_16x16x32_bf16 v[24:27], v[72:75], v[16:19], v[24:27]
    s_waitcnt vmcnt(25)
    ds_read_b128 v[72:75], v3 offset:22528
    v_perm_b32 v20, v41, v41, v1
    v_perm_b32 v21, v41, v41, v2
    v_perm_b32 v22, v41, v41, v13
    v_perm_b32 v23, v41, v41, v15
    s_waitcnt vmcnt(32)
    v_mfma_f32_16x16x32_bf16 v[28:31], v[168:171], v[16:19], v[28:31]
    v_cvt_pk_bf16_f32 v45, v46, v47
    s_add_u32 s10, s80, 1572864
    s_add_u32 m0, s81, 34304
    s_nop 0
    buffer_load_dwordx4 v5, s[44:47], s10 offen offset:1536 nt lds
    s_add_u32 s10, s80, 1572864
    buffer_load_dwordx4 v[236:239], v5, s[44:47], s10 offen offset:1792 nt
    s_waitcnt lgkmcnt(3)
    v_mfma_f32_16x16x32_bf16 v[24:27], v[76:79], v[20:23], v[24:27]
    s_waitcnt vmcnt(25)
    ds_read_b128 v[76:79], v3 offset:23552
    v_perm_b32 v16, v44, v44, v8
    v_perm_b32 v17, v44, v44, v9
    v_perm_b32 v18, v44, v44, v10
    v_perm_b32 v19, v44, v44, v11
    s_waitcnt vmcnt(32)
    v_mfma_f32_16x16x32_bf16 v[28:31], v[172:175], v[20:23], v[28:31]
    v_pk_add_f32 v[6:7], v[6:7], v[46:47]
    s_add_u32 s10, s80, 1835008
    s_add_u32 m0, s81, 36864
    s_nop 0
    buffer_load_dwordx4 v5, s[44:47], s10 offen offset:0 nt lds
    s_add_u32 s10, s80, 1835008
    buffer_load_dwordx4 v[240:243], v5, s[44:47], s10 offen offset:256 nt
    s_waitcnt lgkmcnt(3)
    v_mfma_f32_16x16x32_bf16 v[24:27], v[64:67], v[16:19], v[24:27]
    s_waitcnt vmcnt(25)
    ds_read_b128 v[64:67], v3 offset:24576
    v_perm_b32 v20, v44, v44, v1
    v_perm_b32 v21, v44, v44, v2
    v_perm_b32 v22, v44, v44, v13
    v_perm_b32 v23, v44, v44, v15
    s_waitcnt vmcnt(32)
    v_mfma_f32_16x16x32_bf16 v[28:31], v[176:179], v[16:19], v[28:31]
    v_pk_fma_f32 v[48:49], v[48:49], s[98:99], v[14:15] op_sel:[0,1,0] op_sel_hi:[1,1,0] neg_lo:[0,0,1] neg_hi:[0,0,1]
    v_pk_fma_f32 v[50:51], v[50:51], s[98:99], v[14:15] op_sel:[0,1,0] op_sel_hi:[1,1,0] neg_lo:[0,0,1] neg_hi:[0,0,1]
    v_exp_f32 v48, v48
    v_exp_f32 v49, v49
    s_add_u32 s10, s80, 1835008
    s_add_u32 m0, s81, 37376
    s_nop 0
    buffer_load_dwordx4 v5, s[44:47], s10 offen offset:512 nt lds
    s_add_u32 s10, s80, 1835008
    buffer_load_dwordx4 v[244:247], v5, s[44:47], s10 offen offset:768 nt
    s_waitcnt lgkmcnt(3)
    v_mfma_f32_16x16x32_bf16 v[24:27], v[68:71], v[20:23], v[24:27]
    s_waitcnt vmcnt(25)
    ds_read_b128 v[68:71], v3 offset:25600
    v_perm_b32 v16, v45, v45, v8
    v_perm_b32 v17, v45, v45, v9
    v_perm_b32 v18, v45, v45, v10
    v_perm_b32 v19, v45, v45, v11
    s_waitcnt vmcnt(32)
    v_mfma_f32_16x16x32_bf16 v[28:31], v[180:183], v[20:23], v[28:31]
    v_exp_f32 v50, v50
    v_exp_f32 v51, v51
    v_pk_add_f32 v[6:7], v[6:7], v[48:49]
    v_cvt_pk_bf16_f32 v48, v48, v49
    s_add_u32 s10, s80, 1835008
    s_add_u32 m0, s81, 37888
    s_nop 0
    buffer_load_dwordx4 v5, s[44:47], s10 offen offset:1024 nt lds
    s_add_u32 s10, s80, 1835008
    buffer_load_dwordx4 v[248:251], v5, s[44:47], s10 offen offset:1280 nt
    s_waitcnt lgkmcnt(3)
    v_mfma_f32_16x16x32_bf16 v[24:27], v[72:75], v[16:19], v[24:27]
    s_waitcnt vmcnt(25)
    ds_read_b128 v[72:75], v3 offset:26624
    v_perm_b32 v20, v45, v45, v1
    v_perm_b32 v21, v45, v45, v2
    v_perm_b32 v22, v45, v45, v13
    v_perm_b32 v23, v45, v45, v15
    s_waitcnt vmcnt(32)
    v_mfma_f32_16x16x32_bf16 v[28:31], v[184:187], v[16:19], v[28:31]
    v_cvt_pk_bf16_f32 v49, v50, v51
    s_add_u32 s10, s80, 1835008
    s_add_u32 m0, s81, 38400
    s_nop 0
    buffer_load_dwordx4 v5, s[44:47], s10 offen offset:1536 nt lds
    s_add_u32 s10, s80, 1835008
    buffer_load_dwordx4 v[252:255], v5, s[44:47], s10 offen offset:1792 nt
    s_waitcnt lgkmcnt(3)
    v_mfma_f32_16x16x32_bf16 v[24:27], v[76:79], v[20:23], v[24:27]
    s_waitcnt vmcnt(25)
    ds_read_b128 v[76:79], v3 offset:27648
    v_perm_b32 v16, v48, v48, v8
    v_perm_b32 v17, v48, v48, v9
    v_perm_b32 v18, v48, v48, v10
    v_perm_b32 v19, v48, v48, v11
    s_waitcnt vmcnt(32)
    v_mfma_f32_16x16x32_bf16 v[28:31], v[188:191], v[20:23], v[28:31]
    v_pk_add_f32 v[6:7], v[6:7], v[50:51]
    s_waitcnt lgkmcnt(3)
    v_mfma_f32_16x16x32_bf16 v[24:27], v[64:67], v[16:19], v[24:27]
    s_waitcnt vmcnt(23)
    ds_read_b128 v[64:67], v3 offset:28672
    v_perm_b32 v20, v48, v48, v1
    v_perm_b32 v21, v48, v48, v2
    v_perm_b32 v22, v48, v48, v13
    v_perm_b32 v23, v48, v48, v15
    s_waitcnt vmcnt(30)
    v_mfma_f32_16x16x32_bf16 v[28:31], v[192:195], v[16:19], v[28:31]
    v_pk_fma_f32 v[52:53], v[52:53], s[98:99], v[14:15] op_sel:[0,1,0] op_sel_hi:[1,1,0] neg_lo:[0,0,1] neg_hi:[0,0,1]
    v_pk_fma_f32 v[54:55], v[54:55], s[98:99], v[14:15] op_sel:[0,1,0] op_sel_hi:[1,1,0] neg_lo:[0,0,1] neg_hi:[0,0,1]
    v_exp_f32 v52, v52
    v_exp_f32 v53, v53
    s_waitcnt lgkmcnt(3)
    v_mfma_f32_16x16x32_bf16 v[24:27], v[68:71], v[20:23], v[24:27]
    s_waitcnt vmcnt(21)
    ds_read_b128 v[68:71], v3 offset:29696
    v_perm_b32 v16, v49, v49, v8
    v_perm_b32 v17, v49, v49, v9
    v_perm_b32 v18, v49, v49, v10
    v_perm_b32 v19, v49, v49, v11
    s_waitcnt vmcnt(28)
    v_mfma_f32_16x16x32_bf16 v[28:31], v[196:199], v[20:23], v[28:31]
    v_exp_f32 v54, v54
    v_exp_f32 v55, v55
    v_pk_add_f32 v[6:7], v[6:7], v[52:53]
    v_cvt_pk_bf16_f32 v52, v52, v53
    s_waitcnt lgkmcnt(3)
    v_mfma_f32_16x16x32_bf16 v[24:27], v[72:75], v[16:19], v[24:27]
    s_waitcnt vmcnt(19)
    ds_read_b128 v[72:75], v3 offset:30720
    v_perm_b32 v20, v49, v49, v1
    v_perm_b32 v21, v49, v49, v2
    v_perm_b32 v22, v49, v49, v13
    v_perm_b32 v23, v49, v49, v15
    s_waitcnt vmcnt(26)
    v_mfma_f32_16x16x32_bf16 v[28:31], v[200:203], v[16:19], v[28:31]
    v_cvt_pk_bf16_f32 v53, v54, v55
    s_waitcnt lgkmcnt(3)
    v_mfma_f32_16x16x32_bf16 v[24:27], v[76:79], v[20:23], v[24:27]
    s_waitcnt vmcnt(17)
    ds_read_b128 v[76:79], v3 offset:31744
    v_perm_b32 v16, v52, v52, v8
    v_perm_b32 v17, v52, v52, v9
    v_perm_b32 v18, v52, v52, v10
    v_perm_b32 v19, v52, v52, v11
    s_waitcnt vmcnt(24)
    v_mfma_f32_16x16x32_bf16 v[28:31], v[204:207], v[20:23], v[28:31]
    v_pk_add_f32 v[6:7], v[6:7], v[54:55]
    s_waitcnt lgkmcnt(3)
    v_mfma_f32_16x16x32_bf16 v[24:27], v[64:67], v[16:19], v[24:27]
    s_waitcnt vmcnt(15)
    ds_read_b128 v[64:67], v3 offset:32768
    v_perm_b32 v20, v52, v52, v1
    v_perm_b32 v21, v52, v52, v2
    v_perm_b32 v22, v52, v52, v13
    v_perm_b32 v23, v52, v52, v15
    s_waitcnt vmcnt(22)
    v_mfma_f32_16x16x32_bf16 v[28:31], v[208:211], v[16:19], v[28:31]
    v_pk_fma_f32 v[56:57], v[56:57], s[98:99], v[14:15] op_sel:[0,1,0] op_sel_hi:[1,1,0] neg_lo:[0,0,1] neg_hi:[0,0,1]
    v_pk_fma_f32 v[58:59], v[58:59], s[98:99], v[14:15] op_sel:[0,1,0] op_sel_hi:[1,1,0] neg_lo:[0,0,1] neg_hi:[0,0,1]
    v_exp_f32 v56, v56
    v_exp_f32 v57, v57
    s_waitcnt lgkmcnt(3)
    v_mfma_f32_16x16x32_bf16 v[24:27], v[68:71], v[20:23], v[24:27]
    s_waitcnt vmcnt(13)
    ds_read_b128 v[68:71], v3 offset:33792
    v_perm_b32 v16, v53, v53, v8
    v_perm_b32 v17, v53, v53, v9
    v_perm_b32 v18, v53, v53, v10
    v_perm_b32 v19, v53, v53, v11
    s_waitcnt vmcnt(20)
    v_mfma_f32_16x16x32_bf16 v[28:31], v[212:215], v[20:23], v[28:31]
    v_exp_f32 v58, v58
    v_exp_f32 v59, v59
    v_pk_add_f32 v[6:7], v[6:7], v[56:57]
    v_cvt_pk_bf16_f32 v56, v56, v57
    s_waitcnt lgkmcnt(3)
    v_mfma_f32_16x16x32_bf16 v[24:27], v[72:75], v[16:19], v[24:27]
    s_waitcnt vmcnt(11)
    ds_read_b128 v[72:75], v3 offset:34816
    v_perm_b32 v20, v53, v53, v1
    v_perm_b32 v21, v53, v53, v2
    v_perm_b32 v22, v53, v53, v13
    v_perm_b32 v23, v53, v53, v15
    s_waitcnt vmcnt(18)
    v_mfma_f32_16x16x32_bf16 v[28:31], v[216:219], v[16:19], v[28:31]
    v_cvt_pk_bf16_f32 v57, v58, v59
    s_waitcnt lgkmcnt(3)
    v_mfma_f32_16x16x32_bf16 v[24:27], v[76:79], v[20:23], v[24:27]
    s_waitcnt vmcnt(9)
    ds_read_b128 v[76:79], v3 offset:35840
    v_perm_b32 v16, v56, v56, v8
    v_perm_b32 v17, v56, v56, v9
    v_perm_b32 v18, v56, v56, v10
    v_perm_b32 v19, v56, v56, v11
    s_waitcnt vmcnt(16)
    v_mfma_f32_16x16x32_bf16 v[28:31], v[220:223], v[20:23], v[28:31]
    v_pk_add_f32 v[6:7], v[6:7], v[58:59]
    s_waitcnt lgkmcnt(3)
    v_mfma_f32_16x16x32_bf16 v[24:27], v[64:67], v[16:19], v[24:27]
    s_waitcnt vmcnt(7)
    ds_read_b128 v[64:67], v3 offset:36864
    v_perm_b32 v20, v56, v56, v1
    v_perm_b32 v21, v56, v56, v2
    v_perm_b32 v22, v56, v56, v13
    v_perm_b32 v23, v56, v56, v15
    s_waitcnt vmcnt(14)
    v_mfma_f32_16x16x32_bf16 v[28:31], v[224:227], v[16:19], v[28:31]
    v_pk_fma_f32 v[60:61], v[60:61], s[98:99], v[14:15] op_sel:[0,1,0] op_sel_hi:[1,1,0] neg_lo:[0,0,1] neg_hi:[0,0,1]
    v_pk_fma_f32 v[62:63], v[62:63], s[98:99], v[14:15] op_sel:[0,1,0] op_sel_hi:[1,1,0] neg_lo:[0,0,1] neg_hi:[0,0,1]
    v_exp_f32 v60, v60
    v_exp_f32 v61, v61
    s_waitcnt lgkmcnt(3)
    v_mfma_f32_16x16x32_bf16 v[24:27], v[68:71], v[20:23], v[24:27]
    s_waitcnt vmcnt(5)
    ds_read_b128 v[68:71], v3 offset:37888
    v_perm_b32 v16, v57, v57, v8
    v_perm_b32 v17, v57, v57, v9
    v_perm_b32 v18, v57, v57, v10
    v_perm_b32 v19, v57, v57, v11
    s_waitcnt vmcnt(12)
    v_mfma_f32_16x16x32_bf16 v[28:31], v[228:231], v[20:23], v[28:31]
    v_exp_f32 v62, v62
    v_exp_f32 v63, v63
    v_pk_add_f32 v[6:7], v[6:7], v[60:61]
    v_cvt_pk_bf16_f32 v60, v60, v61
    s_waitcnt lgkmcnt(3)
    v_mfma_f32_16x16x32_bf16 v[24:27], v[72:75], v[16:19], v[24:27]
    s_waitcnt vmcnt(3)
    ds_read_b128 v[72:75], v3 offset:38912
    v_perm_b32 v20, v57, v57, v1
    v_perm_b32 v21, v57, v57, v2
    v_perm_b32 v22, v57, v57, v13
    v_perm_b32 v23, v57, v57, v15
    s_waitcnt vmcnt(10)
    v_mfma_f32_16x16x32_bf16 v[28:31], v[232:235], v[16:19], v[28:31]
    v_cvt_pk_bf16_f32 v61, v62, v63
    s_waitcnt lgkmcnt(3)
    v_mfma_f32_16x16x32_bf16 v[24:27], v[76:79], v[20:23], v[24:27]
    s_waitcnt vmcnt(1)
    ds_read_b128 v[76:79], v3 offset:39936
    v_perm_b32 v16, v60, v60, v8
    v_perm_b32 v17, v60, v60, v9
    v_perm_b32 v18, v60, v60, v10
    v_perm_b32 v19, v60, v60, v11
    s_waitcnt vmcnt(8)
    v_mfma_f32_16x16x32_bf16 v[28:31], v[236:239], v[20:23], v[28:31]
    v_pk_add_f32 v[6:7], v[6:7], v[62:63]
    s_waitcnt lgkmcnt(3)
    v_mfma_f32_16x16x32_bf16 v[24:27], v[64:67], v[16:19], v[24:27]
    v_perm_b32 v20, v60, v60, v1
    v_perm_b32 v21, v60, v60, v2
    v_perm_b32 v22, v60, v60, v13
    v_perm_b32 v23, v60, v60, v15
    s_waitcnt vmcnt(6)
    v_mfma_f32_16x16x32_bf16 v[28:31], v[240:243], v[16:19], v[28:31]
    s_waitcnt lgkmcnt(2)
    v_mfma_f32_16x16x32_bf16 v[24:27], v[68:71], v[20:23], v[24:27]
    v_perm_b32 v16, v61, v61, v8
    v_perm_b32 v17, v61, v61, v9
    v_perm_b32 v18, v61, v61, v10
    v_perm_b32 v19, v61, v61, v11
    s_waitcnt vmcnt(4)
    v_mfma_f32_16x16x32_bf16 v[28:31], v[244:247], v[20:23], v[28:31]
    s_waitcnt lgkmcnt(1)
    v_mfma_f32_16x16x32_bf16 v[24:27], v[72:75], v[16:19], v[24:27]
    v_perm_b32 v20, v61, v61, v1
    v_perm_b32 v21, v61, v61, v2
    v_perm_b32 v22, v61, v61, v13
    v_perm_b32 v23, v61, v61, v15
    s_waitcnt vmcnt(2)
    v_mfma_f32_16x16x32_bf16 v[28:31], v[248:251], v[16:19], v[28:31]
    s_waitcnt lgkmcnt(0)
    v_mfma_f32_16x16x32_bf16 v[24:27], v[76:79], v[20:23], v[24:27]
    s_waitcnt vmcnt(0)
    v_mfma_f32_16x16x32_bf16 v[28:31], v[252:255], v[20:23], v[28:31]
    v_add_f32 v13, v6, v7
    s_cmp_lg_u32 s7, 0
    s_cbranch_scc1 Lcnt2d
    s_waitcnt vmcnt(14)
    v_and_b32 v6, 15, v0
    v_cmp_gt_u32 vcc, 8, v6
    v_mov_b32 v7, 24
    v_lshlrev_b32 v6, 4, v6
    v_cndmask_b32 v7, v7, 8, vcc
    s_mov_b32 s98, 0
Lcnt2:
    v_cmp_gt_u32 vcc, v7, v4
    s_cbranch_vccz Lcnt2d
    buffer_load_dword v4, v6, s[76:79], 0 offen sc1
    s_waitcnt vmcnt(0)
    s_add_u32 s98, s98, 1
    s_cmp_lt_u32 s98, 0x8000
    s_cbranch_scc1 Lcnt2
Lcnt2d:
    s_barrier
    s_cmp_lg_u32 s7, 0
    s_cbranch_scc1 Lef15
    s_sub_u32 s8, s85, 0x5c000
    s_lshr_b32 s9, s8, 7
    s_lshl_b32 s9, s9, 5
    s_lshl_b32 s8, s6, 2
    s_add_u32 s8, s8, s9
    s_add_u32 s8, s8, s86
    s_add_u32 s8, s8, 0x5d000
    v_mov_b32 v4, 0
    s_mov_b64 exec, 1
    buffer_store_dword v4, v4, s[64:67], s8 offen sc1
    s_mov_b64 exec, -1
Lef15:
    s_branch Lepi
Lqpoll1:
    s_cmp_lg_u32 s7, 0
    s_cbranch_scc1 Lwk16
    s_mov_b32 s98, 0
    buffer_load_dwordx4 v[60:63], v1, s[64:67], s90 offen sc1
Lpp17:
    s_waitcnt vmcnt(0)
    v_max3_u32 v15, v60, v61, v62
    v_max_u32 v15, v15, v63
    v_cmp_eq_u32 vcc, -1, v15
    s_cbranch_vccz Lpp17_0
    buffer_load_dwordx4 v[60:63], v1, s[64:67], s90 offen sc1
    s_add_u32 s98, s98, 1
    s_cmp_lt_u32 s98, 0x4000
    s_cbranch_scc1 Lpp17
Lpp17_0:
    ds_write_b128 v1, v[60:63] offset:8192
Lpp17d:
Lwk16:
    s_waitcnt lgkmcnt(0)
    s_barrier
    ds_read_b128 v[16:19], v2 offset:8192
    ds_read_b128 v[20:23], v2 offset:8256
    ds_read_b128 v[24:27], v2 offset:8320
    ds_read_b128 v[28:31], v2 offset:8384
    ds_read_b128 v[64:67], v2 offset:8448
    ds_read_b128 v[68:71], v2 offset:8512
    ds_read_b128 v[72:75], v2 offset:8576
    ds_read_b128 v[76:79], v2 offset:8640
    s_waitcnt lgkmcnt(7)
    v_mfma_f32_16x16x32_bf16 v[32:35], a[0:3], v[16:19], 0
    v_lshrrev_b32 v6, 2, v8
    v_mfma_f32_16x16x32_bf16 v[36:39], a[32:35], v[16:19], 0
    v_bfi_b32 v6, v6, 0, s91
    s_waitcnt lgkmcnt(6)
    v_mfma_f32_16x16x32_bf16 v[32:35], a[4:7], v[20:23], v[32:35]
    v_or_b32 v1, v6, v8
    v_mfma_f32_16x16x32_bf16 v[36:39], a[36:39], v[20:23], v[36:39]
    v_lshrrev_b32 v6, 2, v9
    s_waitcnt lgkmcnt(5)
    v_mfma_f32_16x16x32_bf16 v[32:35], a[8:11], v[24:27], v[32:35]
    v_bfi_b32 v6, v6, 0, s91
    v_mfma_f32_16x16x32_bf16 v[36:39], a[40:43], v[24:27], v[36:39]
    v_or_b32 v2, v6, v9
    s_waitcnt lgkmcnt(4)
    v_mfma_f32_16x16x32_bf16 v[32:35], a[12:15], v[28:31], v[32:35]
    v_lshrrev_b32 v6, 2, v10
    v_mfma_f32_16x16x32_bf16 v[36:39], a[44:47], v[28:31], v[36:39]
    v_bfi_b32 v6, v6, 0, s91
    s_waitcnt lgkmcnt(3)
    v_mfma_f32_16x16x32_bf16 v[32:35], a[16:19], v[64:67], v[32:35]
    v_or_b32 v13, v6, v10
    v_mfma_f32_16x16x32_bf16 v[36:39], a[48:51], v[64:67], v[36:39]
    v_lshrrev_b32 v6, 2, v11
    s_waitcnt lgkmcnt(2)
    v_mfma_f32_16x16x32_bf16 v[32:35], a[20:23], v[68:71], v[32:35]
    v_bfi_b32 v6, v6, 0, s91
    v_or_b32 v15, v6, v11
    v_mfma_f32_16x16x32_bf16 v[36:39], a[52:55], v[68:71], v[36:39]
    s_waitcnt lgkmcnt(1)
    v_mfma_f32_16x16x32_bf16 v[32:35], a[24:27], v[72:75], v[32:35]
    v_mfma_f32_16x16x32_bf16 v[36:39], a[56:59], v[72:75], v[36:39]
    s_waitcnt lgkmcnt(0)
    v_mfma_f32_16x16x32_bf16 v[32:35], a[28:31], v[76:79], v[32:35]
    v_mfma_f32_16x16x32_bf16 v[36:39], a[60:63], v[76:79], v[36:39]
    v_mfma_f32_16x16x32_bf16 v[40:43], a[64:67], v[16:19], 0
    v_mfma_f32_16x16x32_bf16 v[44:47], a[96:99], v[16:19], 0
    v_mfma_f32_16x16x32_bf16 v[40:43], a[68:71], v[20:23], v[40:43]
    v_mfma_f32_16x16x32_bf16 v[44:47], a[100:103], v[20:23], v[44:47]
    v_cvt_pk_bf16_f32 v6, v32, v33
    v_mfma_f32_16x16x32_bf16 v[40:43], a[72:75], v[24:27], v[40:43]
    v_cvt_pk_bf16_f32 v7, v34, v35
    v_mfma_f32_16x16x32_bf16 v[44:47], a[104:107], v[24:27], v[44:47]
    v_lshlrev_b32 v32, 16, v6
    v_mfma_f32_16x16x32_bf16 v[40:43], a[76:79], v[28:31], v[40:43]
    v_and_b32 v33, 0xffff0000, v6
    v_mfma_f32_16x16x32_bf16 v[44:47], a[108:111], v[28:31], v[44:47]
    v_lshlrev_b32 v34, 16, v7
    v_mfma_f32_16x16x32_bf16 v[40:43], a[80:83], v[64:67], v[40:43]
    v_and_b32 v35, 0xffff0000, v7
    v_mfma_f32_16x16x32_bf16 v[44:47], a[112:115], v[64:67], v[44:47]
    v_max_f32 v12, v32, v33
    v_mfma_f32_16x16x32_bf16 v[40:43], a[84:87], v[68:71], v[40:43]
    v_max3_f32 v12, v12, v34, v35
    v_cvt_pk_bf16_f32 v6, v36, v37
    v_mfma_f32_16x16x32_bf16 v[44:47], a[116:119], v[68:71], v[44:47]
    v_cvt_pk_bf16_f32 v7, v38, v39
    v_lshlrev_b32 v36, 16, v6
    v_mfma_f32_16x16x32_bf16 v[40:43], a[88:91], v[72:75], v[40:43]
    v_and_b32 v37, 0xffff0000, v6
    v_lshlrev_b32 v38, 16, v7
    v_mfma_f32_16x16x32_bf16 v[44:47], a[120:123], v[72:75], v[44:47]
    v_and_b32 v39, 0xffff0000, v7
    v_max3_f32 v12, v12, v36, v37
    v_mfma_f32_16x16x32_bf16 v[40:43], a[92:95], v[76:79], v[40:43]
    v_max3_f32 v12, v12, v38, v39
    v_mfma_f32_16x16x32_bf16 v[44:47], a[124:127], v[76:79], v[44:47]
    v_mfma_f32_16x16x32_bf16 v[48:51], a[128:131], v[16:19], 0
    v_mfma_f32_16x16x32_bf16 v[52:55], a[160:163], v[16:19], 0
    v_mfma_f32_16x16x32_bf16 v[48:51], a[132:135], v[20:23], v[48:51]
    v_mfma_f32_16x16x32_bf16 v[52:55], a[164:167], v[20:23], v[52:55]
    v_cvt_pk_bf16_f32 v6, v40, v41
    v_mfma_f32_16x16x32_bf16 v[48:51], a[136:139], v[24:27], v[48:51]
    v_cvt_pk_bf16_f32 v7, v42, v43
    v_mfma_f32_16x16x32_bf16 v[52:55], a[168:171], v[24:27], v[52:55]
    v_lshlrev_b32 v40, 16, v6
    v_mfma_f32_16x16x32_bf16 v[48:51], a[140:143], v[28:31], v[48:51]
    v_and_b32 v41, 0xffff0000, v6
    v_mfma_f32_16x16x32_bf16 v[52:55], a[172:175], v[28:31], v[52:55]
    v_lshlrev_b32 v42, 16, v7
    v_mfma_f32_16x16x32_bf16 v[48:51], a[144:147], v[64:67], v[48:51]
    v_and_b32 v43, 0xffff0000, v7
    v_mfma_f32_16x16x32_bf16 v[52:55], a[176:179], v[64:67], v[52:55]
    v_max3_f32 v12, v12, v40, v41
    v_mfma_f32_16x16x32_bf16 v[48:51], a[148:151], v[68:71], v[48:51]
    v_max3_f32 v12, v12, v42, v43
    v_cvt_pk_bf16_f32 v6, v44, v45
    v_mfma_f32_16x16x32_bf16 v[52:55], a[180:183], v[68:71], v[52:55]
    v_cvt_pk_bf16_f32 v7, v46, v47
    v_lshlrev_b32 v44, 16, v6
    v_mfma_f32_16x16x32_bf16 v[48:51], a[152:155], v[72:75], v[48:51]
    v_and_b32 v45, 0xffff0000, v6
    v_lshlrev_b32 v46, 16, v7
    v_mfma_f32_16x16x32_bf16 v[52:55], a[184:187], v[72:75], v[52:55]
    v_and_b32 v47, 0xffff0000, v7
    v_max3_f32 v12, v12, v44, v45
    v_mfma_f32_16x16x32_bf16 v[48:51], a[156:159], v[76:79], v[48:51]
    v_max3_f32 v12, v12, v46, v47
    v_mfma_f32_16x16x32_bf16 v[52:55], a[188:191], v[76:79], v[52:55]
    s_waitcnt vmcnt(0)
    v_mfma_f32_16x16x32_bf16 v[56:59], a[192:195], v[16:19], 0
    v_mfma_f32_16x16x32_bf16 v[60:63], a[224:227], v[16:19], 0
    v_mfma_f32_16x16x32_bf16 v[56:59], a[196:199], v[20:23], v[56:59]
    v_mfma_f32_16x16x32_bf16 v[60:63], a[228:231], v[20:23], v[60:63]
    v_cvt_pk_bf16_f32 v6, v48, v49
    v_mfma_f32_16x16x32_bf16 v[56:59], a[200:203], v[24:27], v[56:59]
    v_cvt_pk_bf16_f32 v7, v50, v51
    v_mfma_f32_16x16x32_bf16 v[60:63], a[232:235], v[24:27], v[60:63]
    v_lshlrev_b32 v48, 16, v6
    v_mfma_f32_16x16x32_bf16 v[56:59], a[204:207], v[28:31], v[56:59]
    v_and_b32 v49, 0xffff0000, v6
    v_mfma_f32_16x16x32_bf16 v[60:63], a[236:239], v[28:31], v[60:63]
    v_lshlrev_b32 v50, 16, v7
    v_mfma_f32_16x16x32_bf16 v[56:59], a[208:211], v[64:67], v[56:59]
    v_and_b32 v51, 0xffff0000, v7
    v_mfma_f32_16x16x32_bf16 v[60:63], a[240:243], v[64:67], v[60:63]
    v_max3_f32 v12, v12, v48, v49
    v_mfma_f32_16x16x32_bf16 v[56:59], a[212:215], v[68:71], v[56:59]
    v_max3_f32 v12, v12, v50, v51
    v_cvt_pk_bf16_f32 v6, v52, v53
    v_mfma_f32_16x16x32_bf16 v[60:63], a[244:247], v[68:71], v[60:63]
    v_cvt_pk_bf16_f32 v7, v54, v55
    v_lshlrev_b32 v52, 16, v6
    v_mfma_f32_16x16x32_bf16 v[56:59], a[216:219], v[72:75], v[56:59]
    v_and_b32 v53, 0xffff0000, v6
    v_lshlrev_b32 v54, 16, v7
    v_mfma_f32_16x16x32_bf16 v[60:63], a[248:251], v[72:75], v[60:63]
    v_and_b32 v55, 0xffff0000, v7
    v_max3_f32 v12, v12, v52, v53
    v_mfma_f32_16x16x32_bf16 v[56:59], a[220:223], v[76:79], v[56:59]
    v_max3_f32 v12, v12, v54, v55
    v_mfma_f32_16x16x32_bf16 v[60:63], a[252:255], v[76:79], v[60:63]
    ds_read_b128 v[64:67], v3 offset:4096
    ds_read_b128 v[68:71], v3 offset:5120
    ds_read_b128 v[72:75], v3 offset:6144
    ds_read_b128 v[76:79], v3 offset:7168
    s_nop 3
    v_cvt_pk_bf16_f32 v6, v56, v57
    v_cvt_pk_bf16_f32 v7, v58, v59
    v_lshlrev_b32 v56, 16, v6
    v_and_b32 v57, 0xffff0000, v6
    v_lshlrev_b32 v58, 16, v7
    v_and_b32 v59, 0xffff0000, v7
    v_max3_f32 v12, v12, v56, v57
    v_max3_f32 v12, v12, v58, v59
    v_cvt_pk_bf16_f32 v6, v60, v61
    v_cvt_pk_bf16_f32 v7, v62, v63
    v_lshlrev_b32 v60, 16, v6
    v_and_b32 v61, 0xffff0000, v6
    v_lshlrev_b32 v62, 16, v7
    v_and_b32 v63, 0xffff0000, v7
    v_max3_f32 v12, v12, v60, v61
    v_max3_f32 v12, v12, v62, v63
    v_mov_b32 v6, v12
    s_nop 1
    v_permlane16_swap_b32 v12, v6
    s_nop 1
    v_max_f32 v12, v12, v6
    v_mov_b32 v6, v12
    s_nop 1
    v_permlane32_swap_b32 v12, v6
    v_mov_b32 v7, 0
    s_nop 0
    v_max_f32 v12, v12, v6
    v_mul_f32 v14, s99, v12
    v_mov_b32 v6, 0
    v_pk_fma_f32 v[32:33], v[32:33], s[98:99], v[14:15] op_sel:[0,1,0] op_sel_hi:[1,1,0] neg_lo:[0,0,1] neg_hi:[0,0,1]
    v_pk_fma_f32 v[34:35], v[34:35], s[98:99], v[14:15] op_sel:[0,1,0] op_sel_hi:[1,1,0] neg_lo:[0,0,1] neg_hi:[0,0,1]
    v_exp_f32 v32, v32
    v_exp_f32 v33, v33
    v_exp_f32 v34, v34
    v_exp_f32 v35, v35
    v_pk_add_f32 v[6:7], v[6:7], v[32:33]
    v_cvt_pk_bf16_f32 v32, v32, v33
    v_cvt_pk_bf16_f32 v33, v34, v35
    v_pk_add_f32 v[6:7], v[6:7], v[34:35]
    v_perm_b32 v16, v32, v32, v8
    v_perm_b32 v17, v32, v32, v9
    v_perm_b32 v18, v32, v32, v10
    v_perm_b32 v19, v32, v32, v11
    s_nop 0
    s_waitcnt lgkmcnt(3)
    v_mfma_f32_16x16x32_bf16 v[24:27], v[64:67], v[16:19], 0
    ds_read_b128 v[64:67], v3 offset:8192
    v_perm_b32 v20, v32, v32, v1
    v_perm_b32 v21, v32, v32, v2
    v_perm_b32 v22, v32, v32, v13
    v_perm_b32 v23, v32, v32, v15
    s_waitcnt lgkmcnt(3)
    v_mfma_f32_16x16x32_bf16 v[28:31], v[68:71], v[16:19], 0
    ds_read_b128 v[68:71], v3 offset:9216
    v_pk_fma_f32 v[36:37], v[36:37], s[98:99], v[14:15] op_sel:[0,1,0] op_sel_hi:[1,1,0] neg_lo:[0,0,1] neg_hi:[0,0,1]
    v_pk_fma_f32 v[38:39], v[38:39], s[98:99], v[14:15] op_sel:[0,1,0] op_sel_hi:[1,1,0] neg_lo:[0,0,1] neg_hi:[0,0,1]
    v_exp_f32 v36, v36
    v_exp_f32 v37, v37
    s_waitcnt lgkmcnt(3)
    v_mfma_f32_16x16x32_bf16 v[24:27], v[72:75], v[20:23], v[24:27]
    ds_read_b128 v[72:75], v3 offset:10240
    v_perm_b32 v16, v33, v33, v8
    v_perm_b32 v17, v33, v33, v9
    v_perm_b32 v18, v33, v33, v10
    v_perm_b32 v19, v33, v33, v11
    s_waitcnt lgkmcnt(3)
    v_mfma_f32_16x16x32_bf16 v[28:31], v[76:79], v[20:23], v[28:31]
    ds_read_b128 v[76:79], v3 offset:11264
    v_exp_f32 v38, v38
    v_exp_f32 v39, v39
    v_pk_add_f32 v[6:7], v[6:7], v[36:37]
    v_cvt_pk_bf16_f32 v36, v36, v37
    s_waitcnt lgkmcnt(3)
    v_mfma_f32_16x16x32_bf16 v[24:27], v[64:67], v[16:19], v[24:27]
    ds_read_b128 v[64:67], v3 offset:12288
    v_perm_b32 v20, v33, v33, v1
    v_perm_b32 v21, v33, v33, v2
    v_perm_b32 v22, v33, v33, v13
    v_perm_b32 v23, v33, v33, v15
    s_waitcnt lgkmcnt(3)
    v_mfma_f32_16x16x32_bf16 v[28:31], v[68:71], v[16:19], v[28:31]
    ds_read_b128 v[68:71], v3 offset:13312
    v_cvt_pk_bf16_f32 v37, v38, v39
    s_waitcnt lgkmcnt(3)
    v_mfma_f32_16x16x32_bf16 v[24:27], v[72:75], v[20:23], v[24:27]
    ds_read_b128 v[72:75], v3 offset:14336
    v_perm_b32 v16, v36, v36, v8
    v_perm_b32 v17, v36, v36, v9
    v_perm_b32 v18, v36, v36, v10
    v_perm_b32 v19, v36, v36, v11
    s_waitcnt lgkmcnt(3)
    v_mfma_f32_16x16x32_bf16 v[28:31], v[76:79], v[20:23], v[28:31]
    ds_read_b128 v[76:79], v3 offset:15360
    v_pk_add_f32 v[6:7], v[6:7], v[38:39]
    s_waitcnt lgkmcnt(3)
    v_mfma_f32_16x16x32_bf16 v[24:27], v[64:67], v[16:19], v[24:27]
    ds_read_b128 v[64:67], v3 offset:16384
    v_perm_b32 v20, v36, v36, v1
    v_perm_b32 v21, v36, v36, v2
    v_perm_b32 v22, v36, v36, v13
    v_perm_b32 v23, v36, v36, v15
    v_mfma_f32_16x16x32_bf16 v[28:31], v[144:147], v[16:19], v[28:31]
    v_pk_fma_f32 v[40:41], v[40:41], s[98:99], v[14:15] op_sel:[0,1,0] op_sel_hi:[1,1,0] neg_lo:[0,0,1] neg_hi:[0,0,1]
    v_pk_fma_f32 v[42:43], v[42:43], s[98:99], v[14:15] op_sel:[0,1,0] op_sel_hi:[1,1,0] neg_lo:[0,0,1] neg_hi:[0,0,1]
    v_exp_f32 v40, v40
    v_exp_f32 v41, v41
    s_waitcnt lgkmcnt(3)
    v_mfma_f32_16x16x32_bf16 v[24:27], v[68:71], v[20:23], v[24:27]
    ds_read_b128 v[68:71], v3 offset:17408
    v_perm_b32 v16, v37, v37, v8
    v_perm_b32 v17, v37, v37, v9
    v_perm_b32 v18, v37, v37, v10
    v_perm_b32 v19, v37, v37, v11
    v_mfma_f32_16x16x32_bf16 v[28:31], v[148:151], v[20:23], v[28:31]
    v_exp_f32 v42, v42
    v_exp_f32 v43, v43
    v_pk_add_f32 v[6:7], v[6:7], v[40:41]
    v_cvt_pk_bf16_f32 v40, v40, v41
    s_waitcnt lgkmcnt(3)
    v_mfma_f32_16x16x32_bf16 v[24:27], v[72:75], v[16:19], v[24:27]
    ds_read_b128 v[72:75], v3 offset:18432
    v_perm_b32 v20, v37, v37, v1
    v_perm_b32 v21, v37, v37, v2
    v_perm_b32 v22, v37, v37, v13
    v_perm_b32 v23, v37, v37, v15
    v_mfma_f32_16x16x32_bf16 v[28:31], v[152:155], v[16:19], v[28:31]
    v_cvt_pk_bf16_f32 v41, v42, v43
    s_waitcnt lgkmcnt(3)
    v_mfma_f32_16x16x32_bf16 v[24:27], v[76:79], v[20:23], v[24:27]
    ds_read_b128 v[76:79], v3 offset:19456
    v_perm_b32 v16, v40, v40, v8
    v_perm_b32 v17, v40, v40, v9
    v_perm_b32 v18, v40, v40, v10
    v_perm_b32 v19, v40, v40, v11
    v_mfma_f32_16x16x32_bf16 v[28:31], v[156:159], v[20:23], v[28:31]
    v_pk_add_f32 v[6:7], v[6:7], v[42:43]
    s_waitcnt lgkmcnt(3)
    v_mfma_f32_16x16x32_bf16 v[24:27], v[64:67], v[16:19], v[24:27]
    ds_read_b128 v[64:67], v3 offset:20480
    v_perm_b32 v20, v40, v40, v1
    v_perm_b32 v21, v40, v40, v2
    v_perm_b32 v22, v40, v40, v13
    v_perm_b32 v23, v40, v40, v15
    v_mfma_f32_16x16x32_bf16 v[28:31], v[160:163], v[16:19], v[28:31]
    v_pk_fma_f32 v[44:45], v[44:45], s[98:99], v[14:15] op_sel:[0,1,0] op_sel_hi:[1,1,0] neg_lo:[0,0,1] neg_hi:[0,0,1]
    v_pk_fma_f32 v[46:47], v[46:47], s[98:99], v[14:15] op_sel:[0,1,0] op_sel_hi:[1,1,0] neg_lo:[0,0,1] neg_hi:[0,0,1]
    v_exp_f32 v44, v44
    v_exp_f32 v45, v45
    s_waitcnt lgkmcnt(3)
    v_mfma_f32_16x16x32_bf16 v[24:27], v[68:71], v[20:23], v[24:27]
    ds_read_b128 v[68:71], v3 offset:21504
    v_perm_b32 v16, v41, v41, v8
    v_perm_b32 v17, v41, v41, v9
    v_perm_b32 v18, v41, v41, v10
    v_perm_b32 v19, v41, v41, v11
    v_mfma_f32_16x16x32_bf16 v[28:31], v[164:167], v[20:23], v[28:31]
    v_exp_f32 v46, v46
    v_exp_f32 v47, v47
    v_pk_add_f32 v[6:7], v[6:7], v[44:45]
    v_cvt_pk_bf16_f32 v44, v44, v45
    s_waitcnt lgkmcnt(3)
    v_mfma_f32_16x16x32_bf16 v[24:27], v[72:75], v[16:19], v[24:27]
    ds_read_b128 v[72:75], v3 offset:22528
    v_perm_b32 v20, v41, v41, v1
    v_perm_b32 v21, v41, v41, v2
    v_perm_b32 v22, v41, v41, v13
    v_perm_b32 v23, v41, v41, v15
    v_mfma_f32_16x16x32_bf16 v[28:31], v[168:171], v[16:19], v[28:31]
    v_cvt_pk_bf16_f32 v45, v46, v47
    s_waitcnt lgkmcnt(3)
    v_mfma_f32_16x16x32_bf16 v[24:27], v[76:79], v[20:23], v[24:27]
    ds_read_b128 v[76:79], v3 offset:23552
    v_perm_b32 v16, v44, v44, v8
    v_perm_b32 v17, v44, v44, v9
    v_perm_b32 v18, v44, v44, v10
    v_perm_b32 v19, v44, v44, v11
    v_mfma_f32_16x16x32_bf16 v[28:31], v[172:175], v[20:23], v[28:31]
    v_pk_add_f32 v[6:7], v[6:7], v[46:47]
    s_waitcnt lgkmcnt(3)
    v_mfma_f32_16x16x32_bf16 v[24:27], v[64:67], v[16:19], v[24:27]
    ds_read_b128 v[64:67], v3 offset:24576
    v_perm_b32 v20, v44, v44, v1
    v_perm_b32 v21, v44, v44, v2
    v_perm_b32 v22, v44, v44, v13
    v_perm_b32 v23, v44, v44, v15
    v_mfma_f32_16x16x32_bf16 v[28:31], v[176:179], v[16:19], v[28:31]
    v_pk_fma_f32 v[48:49], v[48:49], s[98:99], v[14:15] op_sel:[0,1,0] op_sel_hi:[1,1,0] neg_lo:[0,0,1] neg_hi:[0,0,1]
    v_pk_fma_f32 v[50:51], v[50:51], s[98:99], v[14:15] op_sel:[0,1,0] op_sel_hi:[1,1,0] neg_lo:[0,0,1] neg_hi:[0,0,1]
    v_exp_f32 v48, v48
    v_exp_f32 v49, v49
    s_waitcnt lgkmcnt(3)
    v_mfma_f32_16x16x32_bf16 v[24:27], v[68:71], v[20:23], v[24:27]
    ds_read_b128 v[68:71], v3 offset:25600
    v_perm_b32 v16, v45, v45, v8
    v_perm_b32 v17, v45, v45, v9
    v_perm_b32 v18, v45, v45, v10
    v_perm_b32 v19, v45, v45, v11
    v_mfma_f32_16x16x32_bf16 v[28:31], v[180:183], v[20:23], v[28:31]
    v_exp_f32 v50, v50
    v_exp_f32 v51, v51
    v_pk_add_f32 v[6:7], v[6:7], v[48:49]
    v_cvt_pk_bf16_f32 v48, v48, v49
    s_waitcnt lgkmcnt(3)
    v_mfma_f32_16x16x32_bf16 v[24:27], v[72:75], v[16:19], v[24:27]
    ds_read_b128 v[72:75], v3 offset:26624
    v_perm_b32 v20, v45, v45, v1
    v_perm_b32 v21, v45, v45, v2
    v_perm_b32 v22, v45, v45, v13
    v_perm_b32 v23, v45, v45, v15
    v_mfma_f32_16x16x32_bf16 v[28:31], v[184:187], v[16:19], v[28:31]
    v_cvt_pk_bf16_f32 v49, v50, v51
    s_waitcnt lgkmcnt(3)
    v_mfma_f32_16x16x32_bf16 v[24:27], v[76:79], v[20:23], v[24:27]
    ds_read_b128 v[76:79], v3 offset:27648
    v_perm_b32 v16, v48, v48, v8
    v_perm_b32 v17, v48, v48, v9
    v_perm_b32 v18, v48, v48, v10
    v_perm_b32 v19, v48, v48, v11
    v_mfma_f32_16x16x32_bf16 v[28:31], v[188:191], v[20:23], v[28:31]
    v_pk_add_f32 v[6:7], v[6:7], v[50:51]
    s_waitcnt lgkmcnt(3)
    v_mfma_f32_16x16x32_bf16 v[24:27], v[64:67], v[16:19], v[24:27]
    ds_read_b128 v[64:67], v3 offset:28672
    v_perm_b32 v20, v48, v48, v1
    v_perm_b32 v21, v48, v48, v2
    v_perm_b32 v22, v48, v48, v13
    v_perm_b32 v23, v48, v48, v15
    v_mfma_f32_16x16x32_bf16 v[28:31], v[192:195], v[16:19], v[28:31]
    v_pk_fma_f32 v[52:53], v[52:53], s[98:99], v[14:15] op_sel:[0,1,0] op_sel_hi:[1,1,0] neg_lo:[0,0,1] neg_hi:[0,0,1]
    v_pk_fma_f32 v[54:55], v[54:55], s[98:99], v[14:15] op_sel:[0,1,0] op_sel_hi:[1,1,0] neg_lo:[0,0,1] neg_hi:[0,0,1]
    v_exp_f32 v52, v52
    v_exp_f32 v53, v53
    s_waitcnt lgkmcnt(3)
    v_mfma_f32_16x16x32_bf16 v[24:27], v[68:71], v[20:23], v[24:27]
    ds_read_b128 v[68:71], v3 offset:29696
    v_perm_b32 v16, v49, v49, v8
    v_perm_b32 v17, v49, v49, v9
    v_perm_b32 v18, v49, v49, v10
    v_perm_b32 v19, v49, v49, v11
    v_mfma_f32_16x16x32_bf16 v[28:31], v[196:199], v[20:23], v[28:31]
    v_exp_f32 v54, v54
    v_exp_f32 v55, v55
    v_pk_add_f32 v[6:7], v[6:7], v[52:53]
    v_cvt_pk_bf16_f32 v52, v52, v53
    s_waitcnt lgkmcnt(3)
    v_mfma_f32_16x16x32_bf16 v[24:27], v[72:75], v[16:19], v[24:27]
    ds_read_b128 v[72:75], v3 offset:30720
    v_perm_b32 v20, v49, v49, v1
    v_perm_b32 v21, v49, v49, v2
    v_perm_b32 v22, v49, v49, v13
    v_perm_b32 v23, v49, v49, v15
    v_mfma_f32_16x16x32_bf16 v[28:31], v[200:203], v[16:19], v[28:31]
    v_cvt_pk_bf16_f32 v53, v54, v55
    s_waitcnt lgkmcnt(3)
    v_mfma_f32_16x16x32_bf16 v[24:27], v[76:79], v[20:23], v[24:27]
    ds_read_b128 v[76:79], v3 offset:31744
    v_perm_b32 v16, v52, v52, v8
    v_perm_b32 v17, v52, v52, v9
    v_perm_b32 v18, v52, v52, v10
    v_perm_b32 v19, v52, v52, v11
    v_mfma_f32_16x16x32_bf16 v[28:31], v[204:207], v[20:23], v[28:31]
    v_pk_add_f32 v[6:7], v[6:7], v[54:55]
    s_waitcnt lgkmcnt(3)
    v_mfma_f32_16x16x32_bf16 v[24:27], v[64:67], v[16:19], v[24:27]
    ds_read_b128 v[64:67], v3 offset:32768
    v_perm_b32 v20, v52, v52, v1
    v_perm_b32 v21, v52, v52, v2
    v_perm_b32 v22, v52, v52, v13
    v_perm_b32 v23, v52, v52, v15
    v_mfma_f32_16x16x32_bf16 v[28:31], v[208:211], v[16:19], v[28:31]
    v_pk_fma_f32 v[56:57], v[56:57], s[98:99], v[14:15] op_sel:[0,1,0] op_sel_hi:[1,1,0] neg_lo:[0,0,1] neg_hi:[0,0,1]
    v_pk_fma_f32 v[58:59], v[58:59], s[98:99], v[14:15] op_sel:[0,1,0] op_sel_hi:[1,1,0] neg_lo:[0,0,1] neg_hi:[0,0,1]
    v_exp_f32 v56, v56
    v_exp_f32 v57, v57
    s_waitcnt lgkmcnt(3)
    v_mfma_f32_16x16x32_bf16 v[24:27], v[68:71], v[20:23], v[24:27]
    ds_read_b128 v[68:71], v3 offset:33792
    v_perm_b32 v16, v53, v53, v8
    v_perm_b32 v17, v53, v53, v9
    v_perm_b32 v18, v53, v53, v10
    v_perm_b32 v19, v53, v53, v11
    v_mfma_f32_16x16x32_bf16 v[28:31], v[212:215], v[20:23], v[28:31]
    v_exp_f32 v58, v58
    v_exp_f32 v59, v59
    v_pk_add_f32 v[6:7], v[6:7], v[56:57]
    v_cvt_pk_bf16_f32 v56, v56, v57
    s_waitcnt lgkmcnt(3)
    v_mfma_f32_16x16x32_bf16 v[24:27], v[72:75], v[16:19], v[24:27]
    ds_read_b128 v[72:75], v3 offset:34816
    v_perm_b32 v20, v53, v53, v1
    v_perm_b32 v21, v53, v53, v2
    v_perm_b32 v22, v53, v53, v13
    v_perm_b32 v23, v53, v53, v15
    v_mfma_f32_16x16x32_bf16 v[28:31], v[216:219], v[16:19], v[28:31]
    v_cvt_pk_bf16_f32 v57, v58, v59
    s_waitcnt lgkmcnt(3)
    v_mfma_f32_16x16x32_bf16 v[24:27], v[76:79], v[20:23], v[24:27]
    ds_read_b128 v[76:79], v3 offset:35840
    v_perm_b32 v16, v56, v56, v8
    v_perm_b32 v17, v56, v56, v9
    v_perm_b32 v18, v56, v56, v10
    v_perm_b32 v19, v56, v56, v11
    v_mfma_f32_16x16x32_bf16 v[28:31], v[220:223], v[20:23], v[28:31]
    v_pk_add_f32 v[6:7], v[6:7], v[58:59]
    s_cmp_lg_u32 s7, 0
    s_cbranch_scc1 Lef18
    s_sub_u32 s8, s85, 0x5c000
    s_lshr_b32 s9, s8, 7
    s_lshl_b32 s9, s9, 5
    s_lshl_b32 s8, s6, 2
    s_add_u32 s8, s8, s9
    s_add_u32 s8, s8, s86
    s_add_u32 s8, s8, 0x5d000
    v_mov_b32 v4, 0
    s_mov_b64 exec, 1
    buffer_store_dword v4, v4, s[64:67], s8 offen sc1
    s_mov_b64 exec, -1
Lef18:
    s_waitcnt lgkmcnt(3)
    v_mfma_f32_16x16x32_bf16 v[24:27], v[64:67], v[16:19], v[24:27]
    ds_read_b128 v[64:67], v3 offset:36864
    v_perm_b32 v20, v56, v56, v1
    v_perm_b32 v21, v56, v56, v2
    v_perm_b32 v22, v56, v56, v13
    v_perm_b32 v23, v56, v56, v15
    v_mfma_f32_16x16x32_bf16 v[28:31], v[224:227], v[16:19], v[28:31]
    v_pk_fma_f32 v[60:61], v[60:61], s[98:99], v[14:15] op_sel:[0,1,0] op_sel_hi:[1,1,0] neg_lo:[0,0,1] neg_hi:[0,0,1]
    v_pk_fma_f32 v[62:63], v[62:63], s[98:99], v[14:15] op_sel:[0,1,0] op_sel_hi:[1,1,0] neg_lo:[0,0,1] neg_hi:[0,0,1]
    v_exp_f32 v60, v60
    v_exp_f32 v61, v61
    s_waitcnt lgkmcnt(3)
    v_mfma_f32_16x16x32_bf16 v[24:27], v[68:71], v[20:23], v[24:27]
    ds_read_b128 v[68:71], v3 offset:37888
    v_perm_b32 v16, v57, v57, v8
    v_perm_b32 v17, v57, v57, v9
    v_perm_b32 v18, v57, v57, v10
    v_perm_b32 v19, v57, v57, v11
    v_mfma_f32_16x16x32_bf16 v[28:31], v[228:231], v[20:23], v[28:31]
    v_exp_f32 v62, v62
    v_exp_f32 v63, v63
    v_pk_add_f32 v[6:7], v[6:7], v[60:61]
    v_cvt_pk_bf16_f32 v60, v60, v61
    s_waitcnt lgkmcnt(3)
    v_mfma_f32_16x16x32_bf16 v[24:27], v[72:75], v[16:19], v[24:27]
    ds_read_b128 v[72:75], v3 offset:38912
    v_perm_b32 v20, v57, v57, v1
    v_perm_b32 v21, v57, v57, v2
    v_perm_b32 v22, v57, v57, v13
    v_perm_b32 v23, v57, v57, v15
    v_mfma_f32_16x16x32_bf16 v[28:31], v[232:235], v[16:19], v[28:31]
    v_cvt_pk_bf16_f32 v61, v62, v63
    s_waitcnt lgkmcnt(3)
    v_mfma_f32_16x16x32_bf16 v[24:27], v[76:79], v[20:23], v[24:27]
    ds_read_b128 v[76:79], v3 offset:39936
    v_perm_b32 v16, v60, v60, v8
    v_perm_b32 v17, v60, v60, v9
    v_perm_b32 v18, v60, v60, v10
    v_perm_b32 v19, v60, v60, v11
    v_mfma_f32_16x16x32_bf16 v[28:31], v[236:239], v[20:23], v[28:31]
    v_pk_add_f32 v[6:7], v[6:7], v[62:63]
    s_waitcnt lgkmcnt(3)
    v_mfma_f32_16x16x32_bf16 v[24:27], v[64:67], v[16:19], v[24:27]
    v_perm_b32 v20, v60, v60, v1
    v_perm_b32 v21, v60, v60, v2
    v_perm_b32 v22, v60, v60, v13
    v_perm_b32 v23, v60, v60, v15
    v_mfma_f32_16x16x32_bf16 v[28:31], v[240:243], v[16:19], v[28:31]
    s_waitcnt lgkmcnt(2)
    v_mfma_f32_16x16x32_bf16 v[24:27], v[68:71], v[20:23], v[24:27]
    v_perm_b32 v16, v61, v61, v8
    v_perm_b32 v17, v61, v61, v9
    v_perm_b32 v18, v61, v61, v10
    v_perm_b32 v19, v61, v61, v11
    v_mfma_f32_16x16x32_bf16 v[28:31], v[244:247], v[20:23], v[28:31]
    s_waitcnt lgkmcnt(1)
    v_mfma_f32_16x16x32_bf16 v[24:27], v[72:75], v[16:19], v[24:27]
    v_perm_b32 v20, v61, v61, v1
    v_perm_b32 v21, v61, v61, v2
    v_perm_b32 v22, v61, v61, v13
    v_perm_b32 v23, v61, v61, v15
    v_mfma_f32_16x16x32_bf16 v[28:31], v[248:251], v[16:19], v[28:31]
    s_waitcnt lgkmcnt(0)
    v_mfma_f32_16x16x32_bf16 v[24:27], v[76:79], v[20:23], v[24:27]
    v_mfma_f32_16x16x32_bf16 v[28:31], v[252:255], v[20:23], v[28:31]
    v_add_f32 v13, v6, v7
Lepi:
    v_mov_b32 v6, v13
    s_nop 1
    v_permlane16_swap_b32 v13, v6
    s_nop 1
    v_add_f32 v13, v13, v6
    v_mov_b32 v6, v13
    s_nop 1
    v_permlane32_swap_b32 v13, v6
    s_nop 1
    v_add_f32 v13, v13, v6
    v_bfe_u32 v6, v0, 3, 1
    v_lshlrev_b32 v7, 10, v6
    v_bfe_u32 v1, v0, 4, 2
    v_lshl_add_u32 v7, v1, 5, v7
    v_and_b32 v1, 7, v0
    v_lshl_add_u32 v7, v1, 2, v7
    s_lshl_b32 s8, s7, 11
    v_add_u32 v7, s8, v7
    s_lshl_b32 s8, s7, 4
    v_lshl_add_u32 v6, v6, 3, s8
    ds_write_b32 v7, v24 offset:0
    ds_write_b32 v7, v25 offset:256
    ds_write_b32 v7, v26 offset:512
    ds_write_b32 v7, v27 offset:768
    ds_write_b32 v7, v28 offset:128
    ds_write_b32 v7, v29 offset:384
    ds_write_b32 v7, v30 offset:640
    ds_write_b32 v7, v31 offset:896
    s_mov_b64 exec, 0x101
    ds_write_b64 v6, v[12:13] offset:16128
    s_mov_b64 exec, -1
    v_lshlrev_b32 v6, 2, v0
    v_lshrrev_b32 v2, 7, v0
    v_lshlrev_b32 v3, 3, v2
    v_lshlrev_b32 v1, 10, v2
    v_bfe_u32 v7, v0, 6, 1
    v_lshl_add_u32 v1, v7, 7, v1
    v_bfe_u32 v7, v0, 2, 2
    v_lshl_add_u32 v1, v7, 8, v1
    v_bfe_u32 v7, v0, 4, 2
    v_lshl_add_u32 v1, v7, 5, v1
    v_and_b32 v7, 3, v0
    v_lshl_add_u32 v1, v7, 3, v1
    v_lshlrev_b32 v7, 6, v2
    s_add_u32 s8, s84, s86
    s_add_u32 s9, s85, s86
    s_waitcnt lgkmcnt(0)
    s_barrier
    ds_read_b64 v[40:41], v3 offset:16128
    ds_read_b64 v[42:43], v3 offset:16144
    ds_read_b64 v[44:45], v3 offset:16160
    ds_read_b64 v[46:47], v3 offset:16176
    ds_read_b64 v[32:33], v1 offset:0
    ds_read_b64 v[34:35], v1 offset:2048
    ds_read_b64 v[36:37], v1 offset:4096
    ds_read_b64 v[38:39], v1 offset:6144
    s_waitcnt lgkmcnt(4)
    v_max_f32 v26, v40, v42
    v_max3_f32 v26, v26, v44, v46
    v_sub_f32 v40, v40, v26
    v_mul_f32 v40, s99, v40
    v_sub_f32 v42, v42, v26
    v_mul_f32 v42, s99, v42
    v_sub_f32 v44, v44, v26
    v_mul_f32 v44, s99, v44
    v_sub_f32 v46, v46, v26
    v_mul_f32 v46, s99, v46
    v_exp_f32 v40, v40
    v_exp_f32 v42, v42
    v_exp_f32 v44, v44
    v_exp_f32 v46, v46
    s_waitcnt lgkmcnt(0)
    v_mul_f32 v24, v40, v32
    v_mul_f32 v25, v40, v33
    v_mul_f32 v27, v40, v41
    v_fmac_f32 v24, v42, v34
    v_fmac_f32 v25, v42, v35
    v_fmac_f32 v27, v42, v43
    v_fmac_f32 v24, v44, v36
    v_fmac_f32 v25, v44, v37
    v_fmac_f32 v27, v44, v45
    v_fmac_f32 v24, v46, v38
    v_fmac_f32 v25, v46, v39
    v_fmac_f32 v27, v46, v47
    v_cvt_pk_bf16_f32 v24, v24, v25
    v_min_u32 v24, -2, v24
    v_min_u32 v26, -2, v26
    v_min_u32 v27, -2, v27
    buffer_store_dword v24, v6, s[64:67], s8 offen sc1
    s_and_b32 s10, s7, 1
    s_cmp_lg_u32 s10, 0
    s_cbranch_scc1 Lnoml
    s_mov_b64 exec, 1
    buffer_store_dwordx2 v[26:27], v7, s[64:67], s9 offen sc1
    s_mov_b64 exec, -1
Lnoml:
    s_cmp_eq_u32 s12, 1
    s_cbranch_scc1 Lg
    s_cmp_eq_u32 s12, 0
    s_cbranch_scc1 Lq
    s_cmp_eq_u32 s12, 3
    s_cbranch_scc1 Lf
    s_mov_b32 s59, 0
    v_and_b32 v15, 63, v0
    v_lshlrev_b32 v1, 3, v15
    v_and_b32 v2, 56, v1
    s_mul_i32 s8, s7, 1088
    v_add_u32 v3, s8, v1
    s_lshl_b32 s8, s7, 3
    s_add_u32 s8, s8, s4
    s_lshl_b32 s9, s8, 13
    s_add_u32 s9, s9, s86
    s_lshl_b32 s10, s88, 9
    s_add_u32 s9, s9, s10
    s_add_u32 s10, s9, 4096
    s_lshl_b32 s11, s8, 7
    s_add_u32 s11, s11, s86
    s_add_u32 s11, s11, 0x5c000
    s_lshl_b32 s8, s88, 6
    s_add_u32 s11, s11, s8
    s_lshl_b32 s58, s4, 1
    s_add_u32 s58, s58, s88
    s_lshl_b32 s58, s58, 3
    s_add_u32 s58, s58, s14
    s_lshl_b32 s58, s58, 6
    s_add_u32 s58, s58, s86
    s_add_u32 s58, s58, 0x58000
    v_mov_b32 v78, 0
    v_bfe_u32 v72, v0, 4, 2
    v_and_b32 v73, 15, v0
    v_add_u32 v73, s89, v73
    v_mul_u32_u24 v72, 896, v72
    v_lshl_add_u32 v73, v73, 1, v72
    s_cmp_eq_u32 s3, 0
    s_cbranch_scc1 Lra
    s_add_u32 s8, s56, 0x52000
    buffer_load_ushort v72, v73, s[64:67], s8 offen sc1
    s_branch Lrb
Lra:
    buffer_load_ushort v72, v73, s[68:71], 0 offen
Lrb:
    s_lshl_b32 s8, s7, 3
    s_add_u32 s8, s8, s4
    s_lshl_b32 s8, s8, 5
    s_add_u32 s8, s8, s86
    s_add_u32 s16, s8, 0x5d000
    v_lshrrev_b32 v6, 1, v2
    s_cmp_eq_u32 s59, 1
    s_cbranch_scc1 Lpfs
    s_mov_b32 s98, 0
    buffer_load_dword v7, v6, s[64:67], s16 offen sc1
Lpp19:
    s_waitcnt vmcnt(0)
    v_cmp_eq_u32 vcc, -1, v7
    s_cbranch_vccz Lpp19_0
    buffer_load_dword v7, v6, s[64:67], s16 offen sc1
    s_add_u32 s98, s98, 1
    s_cmp_lt_u32 s98, 0x4000
    s_cbranch_scc1 Lpp19
Lpp19_0:
Lpp19d:
    s_cmp_eq_u32 s3, 0
    s_cbranch_scc1 Lnodw
    s_branch Lnodw
Lpfs:
Lnodw:
    s_mov_b32 s98, 0
    buffer_load_dwordx2 v[60:61], v2, s[64:67], s11 offen sc1
    buffer_load_dwordx2 v[44:45], v1, s[64:67], s9 offen offset:0 sc1
    buffer_load_dwordx2 v[46:47], v1, s[64:67], s9 offen offset:1024 sc1
    buffer_load_dwordx2 v[48:49], v1, s[64:67], s9 offen offset:2048 sc1
    buffer_load_dwordx2 v[50:51], v1, s[64:67], s9 offen offset:3072 sc1
    buffer_load_dwordx2 v[52:53], v1, s[64:67], s10 offen offset:0 sc1
    buffer_load_dwordx2 v[54:55], v1, s[64:67], s10 offen offset:1024 sc1
    buffer_load_dwordx2 v[56:57], v1, s[64:67], s10 offen offset:2048 sc1
    buffer_load_dwordx2 v[58:59], v1, s[64:67], s10 offen offset:3072 sc1
Lpp20:
    s_waitcnt vmcnt(0)
    v_max3_u32 v15, v44, v45, v46
    v_max3_u32 v15, v15, v47, v48
    v_max3_u32 v15, v15, v49, v50
    v_max3_u32 v15, v15, v51, v52
    v_max3_u32 v15, v15, v53, v54
    v_max3_u32 v15, v15, v55, v56
    v_max3_u32 v15, v15, v57, v58
    v_max3_u32 v15, v15, v59, v60
    v_max_u32 v15, v15, v61
    v_cmp_eq_u32 vcc, -1, v15
    s_cbranch_vccz Lpp20_0
    buffer_load_dwordx2 v[60:61], v2, s[64:67], s11 offen sc1
    buffer_load_dwordx2 v[44:45], v1, s[64:67], s9 offen offset:0 sc1
    buffer_load_dwordx2 v[46:47], v1, s[64:67], s9 offen offset:1024 sc1
    buffer_load_dwordx2 v[48:49], v1, s[64:67], s9 offen offset:2048 sc1
    buffer_load_dwordx2 v[50:51], v1, s[64:67], s9 offen offset:3072 sc1
    buffer_load_dwordx2 v[52:53], v1, s[64:67], s10 offen offset:0 sc1
    buffer_load_dwordx2 v[54:55], v1, s[64:67], s10 offen offset:1024 sc1
    buffer_load_dwordx2 v[56:57], v1, s[64:67], s10 offen offset:2048 sc1
    buffer_load_dwordx2 v[58:59], v1, s[64:67], s10 offen offset:3072 sc1
    s_add_u32 s98, s98, 1
    s_cmp_lt_u32 s98, 0x4000
    s_cbranch_scc1 Lpp20
Lpp20_0:
    v_max_f32_dpp v6, v60, v60 quad_perm:[1,0,3,2] row_mask:0xf bank_mask:0xf
    v_lshlrev_b32 v16, 16, v44
    v_and_b32 v44, 0xffff0000, v44
    v_lshlrev_b32 v17, 16, v45
    v_and_b32 v45, 0xffff0000, v45
    v_max_f32_dpp v6, v6, v6 quad_perm:[2,3,0,1] row_mask:0xf bank_mask:0xf
    v_lshlrev_b32 v18, 16, v46
    v_and_b32 v46, 0xffff0000, v46
    v_lshlrev_b32 v19, 16, v47
    v_and_b32 v47, 0xffff0000, v47
    v_max_f32_dpp v6, v6, v6 row_half_mirror row_mask:0xf bank_mask:0xf
    v_lshlrev_b32 v20, 16, v48
    v_and_b32 v48, 0xffff0000, v48
    v_lshlrev_b32 v21, 16, v49
    v_and_b32 v49, 0xffff0000, v49
    v_sub_f32 v6, v60, v6
    v_mul_f32 v6, s99, v6
    v_exp_f32 v6, v6
    v_lshlrev_b32 v22, 16, v50
    v_and_b32 v50, 0xffff0000, v50
    v_lshlrev_b32 v23, 16, v51
    v_and_b32 v51, 0xffff0000, v51
    v_mul_f32 v7, v6, v61
    v_lshlrev_b32 v24, 16, v52
    v_and_b32 v52, 0xffff0000, v52
    v_lshlrev_b32 v25, 16, v53
    v_and_b32 v53, 0xffff0000, v53
    v_add_f32_dpp v7, v7, v7 quad_perm:[1,0,3,2] row_mask:0xf bank_mask:0xf
    v_lshlrev_b32 v26, 16, v54
    v_and_b32 v54, 0xffff0000, v54
    v_lshlrev_b32 v27, 16, v55
    v_and_b32 v55, 0xffff0000, v55
    v_add_f32_dpp v7, v7, v7 quad_perm:[2,3,0,1] row_mask:0xf bank_mask:0xf
    v_lshlrev_b32 v28, 16, v56
    v_and_b32 v56, 0xffff0000, v56
    v_lshlrev_b32 v29, 16, v57
    v_and_b32 v57, 0xffff0000, v57
    v_add_f32_dpp v7, v7, v7 row_half_mirror row_mask:0xf bank_mask:0xf
    v_lshlrev_b32 v30, 16, v58
    v_and_b32 v58, 0xffff0000, v58
    v_lshlrev_b32 v31, 16, v59
    v_and_b32 v59, 0xffff0000, v59
    v_readlane_b32 s16, v6, 0
    v_readlane_b32 s17, v6, 1
    v_readlane_b32 s18, v6, 2
    v_readlane_b32 s19, v6, 3
    v_readlane_b32 s20, v6, 4
    v_readlane_b32 s21, v6, 5
    v_readlane_b32 s22, v6, 6
    v_readlane_b32 s23, v6, 7
    v_rcp_f32 v7, v7
    v_mul_f32 v32, s16, v16
    v_mul_f32 v33, s16, v44
    v_mul_f32 v34, s16, v17
    v_mul_f32 v35, s16, v45
    v_fmac_f32 v32, s17, v18
    v_fmac_f32 v33, s17, v46
    v_fmac_f32 v34, s17, v19
    v_fmac_f32 v35, s17, v47
    v_fmac_f32 v32, s18, v20
    v_fmac_f32 v33, s18, v48
    v_fmac_f32 v34, s18, v21
    v_fmac_f32 v35, s18, v49
    v_fmac_f32 v32, s19, v22
    v_fmac_f32 v33, s19, v50
    v_fmac_f32 v34, s19, v23
    v_fmac_f32 v35, s19, v51
    v_fmac_f32 v32, s20, v24
    v_fmac_f32 v33, s20, v52
    v_fmac_f32 v34, s20, v25
    v_fmac_f32 v35, s20, v53
    v_fmac_f32 v32, s21, v26
    v_fmac_f32 v33, s21, v54
    v_fmac_f32 v34, s21, v27
    v_fmac_f32 v35, s21, v55
    v_fmac_f32 v32, s22, v28
    v_fmac_f32 v33, s22, v56
    v_fmac_f32 v34, s22, v29
    v_fmac_f32 v35, s22, v57
    v_fmac_f32 v32, s23, v30
    v_fmac_f32 v33, s23, v58
    v_fmac_f32 v34, s23, v31
    v_fmac_f32 v35, s23, v59
Lpp20d:
    v_mul_f32 v32, v32, v7
    v_mul_f32 v33, v33, v7
    v_mul_f32 v34, v34, v7
    v_mul_f32 v35, v35, v7
    v_cvt_pk_bf16_f32 v36, v32, v33
    v_cvt_pk_bf16_f32 v37, v34, v35
    ds_write_b64 v3, v[36:37] offset:8192
    v_bfe_u32 v1, v0, 2, 2
    v_mul_u32_u24 v1, 1088, v1
    v_bfe_u32 v2, v0, 4, 2
    v_lshl_add_u32 v1, v2, 4, v1
    s_waitcnt lgkmcnt(0)
    s_barrier
    ds_read_b128 v[8:11], v1 offset:8192
    ds_read_b128 v[12:15], v1 offset:8256
    ds_read_b128 v[16:19], v1 offset:8320
    ds_read_b128 v[20:23], v1 offset:8384
    ds_read_b128 v[32:35], v1 offset:8448
    ds_read_b128 v[36:39], v1 offset:8512
    ds_read_b128 v[40:43], v1 offset:8576
    s_waitcnt lgkmcnt(6)
    v_mfma_f32_16x16x32_bf16 v[24:27], v[8:11], v[80:83], 0
    ds_read_b128 v[8:11], v1 offset:8640
    s_waitcnt lgkmcnt(6)
    v_mfma_f32_16x16x32_bf16 v[28:31], v[12:15], v[84:87], 0
    s_waitcnt lgkmcnt(5)
    v_mfma_f32_16x16x32_bf16 v[24:27], v[16:19], v[88:91], v[24:27]
    s_waitcnt lgkmcnt(4)
    v_mfma_f32_16x16x32_bf16 v[28:31], v[20:23], v[92:95], v[28:31]
    s_waitcnt lgkmcnt(3)
    v_mfma_f32_16x16x32_bf16 v[24:27], v[32:35], v[96:99], v[24:27]
    s_waitcnt lgkmcnt(2)
    v_mfma_f32_16x16x32_bf16 v[28:31], v[36:39], v[100:103], v[28:31]
    s_waitcnt lgkmcnt(1)
    v_mfma_f32_16x16x32_bf16 v[24:27], v[40:43], v[104:107], v[24:27]
    s_waitcnt lgkmcnt(0)
    v_mfma_f32_16x16x32_bf16 v[28:31], v[8:11], v[108:111], v[28:31]
    v_bfe_u32 v1, v0, 4, 2
    v_and_b32 v2, 15, v0
    s_nop 6
    v_add_f32 v24, v24, v28
    v_rndne_f32 v25, v24
    v_sub_f32 v26, v24, v25
    v_cvt_i32_f32 v25, v25
    v_mul_f32 v26, s96, v26
    v_cvt_i32_f32 v24, v26
    v_lshlrev_b32 v1, 12, v1
    v_lshl_add_u32 v1, v2, 3, v1
    v_ashrrev_i32 v26, 31, v24
    v_add_u32 v25, v25, v26
    v_and_or_b32 v24, v24, s95, 1
    s_lshl_b32 s8, s89, 3
    s_add_u32 s8, s8, s86
    s_add_u32 s8, s8, 0x60000
    v_mov_b32 v74, v24
    v_mov_b32 v75, v25
    buffer_atomic_add_x2 v[24:25], v1, s[64:67], s8 offen sc0 sc1
    s_mov_b32 s98, 0
    s_add_u32 s8, s86, 0x50000
Lxa21r:
    s_waitcnt vmcnt(0)
    v_add_co_u32 v24, vcc, v24, v74
    v_addc_co_u32 v25, vcc, v25, v75, vcc
    v_and_b32 v76, 16, v24
    v_lshlrev_b32 v72, 16, v72
    v_lshrrev_b32 v77, 31, v24
    v_cvt_f32_i32 v24, v24
    v_add_u32 v77, v77, v25
    v_cvt_f32_i32 v77, v77
    v_fmac_f32 v77, s97, v24
    v_cmp_ne_u32 vcc, 0, v76
    v_cvt_pk_bf16_f32 v77, v77, v77
    v_lshlrev_b32 v77, 16, v77
    v_add_f32 v72, v77, v72
    v_cvt_pk_bf16_f32 v72, v72, v72
    s_mov_b64 exec, vcc
    v_min_u16 v72, -2, v72
    buffer_store_short v72, v73, s[64:67], s8 offen sc1
    s_add_u32 s8, s8, 0x1000
    buffer_store_short v72, v73, s[64:67], s8 offen sc1
Lxa21e:
    s_mov_b64 exec, -1
    s_cmp_lg_u32 s88, 0
    s_cbranch_scc1 Lnexts
    s_add_u32 s11, s86, 0x50000
    s_add_u32 s11, s11, s56
    v_and_b32 v15, 63, v0
    v_min_u32 v1, 27, v15
    v_lshlrev_b32 v1, 4, v1
    s_lshl_b32 s8, s7, 12
    s_mul_i32 s9, s4, 448
    s_add_u32 s9, s9, s8
    s_add_u32 s9, s9, s86
    s_add_u32 s9, s9, 0x54000
    s_mul_i32 s8, s7, 1088
    v_add_u32 v2, s8, v1
    s_sub_u32 s10, s9, 0x14000
    s_lshl_b32 s16, s14, 6
    s_add_u32 s16, s16, s10
    v_mov_b32 v64, 0
    s_mov_b32 s98, 0
    buffer_load_dword v65, v64, s[64:67], s16 offen sc1
Lpp22:
    s_waitcnt vmcnt(0)
    v_cmp_eq_u32 vcc, -1, v65
    s_cbranch_vccz Lpp22_0
    buffer_load_dword v65, v64, s[64:67], s16 offen sc1
    s_add_u32 s98, s98, 1
    s_cmp_lt_u32 s98, 0x4000
    s_cbranch_scc1 Lpp22
Lpp22_0:
Lpp22d:
    s_mov_b32 s98, 0
    buffer_load_dwordx4 v[64:67], v1, s[64:67], s9 offen sc1
    buffer_load_dwordx4 v[68:71], v1, s[64:67], s10 offen sc1
Lpp23:
    s_waitcnt vmcnt(0)
    v_max3_u32 v15, v64, v65, v66
    v_max3_u32 v15, v15, v67, v68
    v_max3_u32 v15, v15, v69, v70
    v_max_u32 v15, v15, v71
    v_cmp_eq_u32 vcc, -1, v15
    s_cbranch_vccz Lpp23_0
    buffer_load_dwordx4 v[64:67], v1, s[64:67], s9 offen sc1
    buffer_load_dwordx4 v[68:71], v1, s[64:67], s10 offen sc1
    s_add_u32 s98, s98, 1
    s_cmp_lt_u32 s98, 0x4000
    s_cbranch_scc1 Lpp23
Lpp23_0:
    buffer_load_ushort v72, v73, s[64:67], s11 offen sc1
    v_lshlrev_b32 v16, 16, v64
    v_and_b32 v17, 0xffff0000, v64
    v_lshlrev_b32 v18, 16, v68
    v_and_b32 v19, 0xffff0000, v68
    v_pk_mul_f32 v[16:17], v[16:17], v[18:19]
    v_cvt_pk_bf16_f32 v20, v16, v17
    v_lshlrev_b32 v16, 16, v65
    v_and_b32 v17, 0xffff0000, v65
    v_lshlrev_b32 v18, 16, v69
    v_and_b32 v19, 0xffff0000, v69
    v_pk_mul_f32 v[16:17], v[16:17], v[18:19]
    v_cvt_pk_bf16_f32 v21, v16, v17
    v_lshlrev_b32 v16, 16, v66
    v_and_b32 v17, 0xffff0000, v66
    v_lshlrev_b32 v18, 16, v70
    v_and_b32 v19, 0xffff0000, v70
    v_pk_mul_f32 v[16:17], v[16:17], v[18:19]
    v_cvt_pk_bf16_f32 v22, v16, v17
    v_lshlrev_b32 v16, 16, v67
    v_and_b32 v17, 0xffff0000, v67
    v_lshlrev_b32 v18, 16, v71
    v_and_b32 v19, 0xffff0000, v71
    v_pk_mul_f32 v[16:17], v[16:17], v[18:19]
    v_cvt_pk_bf16_f32 v23, v16, v17
    ds_write_b128 v2, v[20:23] offset:0
Lpp23d:
    v_bfe_u32 v1, v0, 2, 2
    v_mul_u32_u24 v1, 1088, v1
    v_bfe_u32 v2, v0, 4, 2
    v_lshl_add_u32 v1, v2, 4, v1
    s_waitcnt lgkmcnt(0)
    s_barrier
    ds_read_b128 v[32:35], v1 offset:0
    ds_read_b128 v[36:39], v1 offset:64
    ds_read_b128 v[40:43], v1 offset:128
    ds_read_b128 v[44:47], v1 offset:192
    ds_read_b128 v[48:51], v1 offset:256
    ds_read_b128 v[52:55], v1 offset:320
    ds_read_b128 v[56:59], v1 offset:384
    s_waitcnt lgkmcnt(6)
    v_mfma_f32_16x16x32_bf16 v[24:27], v[32:35], v[112:115], 0
    s_waitcnt lgkmcnt(5)
    v_mfma_f32_16x16x32_bf16 v[28:31], v[36:39], v[116:119], 0
    s_waitcnt lgkmcnt(4)
    v_mfma_f32_16x16x32_bf16 v[24:27], v[40:43], v[120:123], v[24:27]
    s_waitcnt lgkmcnt(3)
    v_mfma_f32_16x16x32_bf16 v[28:31], v[44:47], v[124:127], v[28:31]
    s_waitcnt lgkmcnt(2)
    v_mfma_f32_16x16x32_bf16 v[24:27], v[48:51], v[128:131], v[24:27]
    s_waitcnt lgkmcnt(1)
    v_mfma_f32_16x16x32_bf16 v[28:31], v[52:55], v[132:135], v[28:31]
    s_waitcnt lgkmcnt(0)
    v_mfma_f32_16x16x32_bf16 v[24:27], v[56:59], v[136:139], v[24:27]
    v_bfe_u32 v1, v0, 4, 2
    v_and_b32 v2, 15, v0
    s_nop 6
    v_add_f32 v24, v24, v28
    v_rndne_f32 v25, v24
    v_sub_f32 v26, v24, v25
    v_cvt_i32_f32 v25, v25
    v_mul_f32 v26, s96, v26
    v_cvt_i32_f32 v24, v26
    v_lshlrev_b32 v1, 12, v1
    v_lshl_add_u32 v1, v2, 3, v1
    v_ashrrev_i32 v26, 31, v24
    v_add_u32 v25, v25, v26
    v_and_or_b32 v24, v24, s95, 1
    s_lshl_b32 s8, s89, 3
    s_add_u32 s8, s8, s86
    s_add_u32 s8, s8, 0x70000
    v_mov_b32 v74, v24
    v_mov_b32 v75, v25
    buffer_atomic_add_x2 v[24:25], v1, s[64:67], s8 offen sc0 sc1
    s_mov_b32 s98, 0
    s_add_u32 s8, s86, 0x52000
Lxa24r:
    s_waitcnt vmcnt(0)
    v_cmp_eq_u16 vcc, -1, v72
    s_cbranch_vccz Lxa24k
    buffer_load_ushort v72, v73, s[64:67], s11 offen sc1
    s_add_u32 s98, s98, 1
    s_cmp_lt_u32 s98, 0x4000
    s_cbranch_scc1 Lxa24r
    s_waitcnt vmcnt(0)
Lxa24k:
    v_add_co_u32 v24, vcc, v24, v74
    v_addc_co_u32 v25, vcc, v25, v75, vcc
    v_and_b32 v76, 8, v24
    v_lshlrev_b32 v72, 16, v72
    v_lshrrev_b32 v77, 31, v24
    v_cvt_f32_i32 v24, v24
    v_add_u32 v77, v77, v25
    v_cvt_f32_i32 v77, v77
    v_fmac_f32 v77, s97, v24
    v_cmp_ne_u32 vcc, 0, v76
    v_cvt_pk_bf16_f32 v77, v77, v77
    v_lshlrev_b32 v77, 16, v77
    v_add_f32 v72, v77, v72
    v_cvt_pk_bf16_f32 v72, v72, v72
    s_mov_b64 exec, vcc
    s_cmp_eq_u32 s3, 0
    s_cbranch_scc1 Lxa24p
    buffer_store_short v72, v73, s[72:75], 0 offen
    s_branch Lxa24e
Lxa24p:
    v_min_u16 v72, -2, v72
    buffer_store_short v72, v73, s[64:67], s8 offen sc1
    s_add_u32 s8, s8, 0x1000
    buffer_store_short v72, v73, s[64:67], s8 offen sc1
Lxa24e:
    s_mov_b64 exec, -1
    s_branch Lnext
Lg:
    s_add_u32 s91, s86, 0x50000
    v_and_b32 v15, 63, v0
    v_lshlrev_b32 v1, 4, v15
    v_min_u32 v2, 47, v15
    v_lshlrev_b32 v2, 4, v2
    v_add_u32 v2, 1024, v2
    s_mul_i32 s8, s7, 896
    s_add_u32 s8, s8, 12544
    v_lshrrev_b32 v3, 1, v1
    v_add_u32 v3, s8, v3
    v_lshrrev_b32 v14, 1, v2
    v_add_u32 v14, s8, v14
    v_lshrrev_b32 v6, 1, v1
    v_lshrrev_b32 v7, 1, v2
    s_mul_i32 s9, s7, 896
    s_add_u32 s9, s9, s91
    s_add_u32 s9, s9, s56
    s_lshr_b32 s8, s2, 1
    s_and_b32 s8, s8, 7
    s_min_u32 s8, s8, 6
    s_lshl_b32 s8, s8, 7
    s_add_u32 s10, s9, s8
    v_mov_b32 v25, 0
    s_mov_b32 s98, 0
    buffer_load_ushort v72, v25, s[64:67], s10 offen sc1
Lpp26:
    s_waitcnt vmcnt(0)
    v_cmp_eq_u16 vcc, -1, v72
    s_cbranch_vccz Lpp26_0
    buffer_load_ushort v72, v25, s[64:67], s10 offen sc1
    s_add_u32 s98, s98, 1
    s_cmp_lt_u32 s98, 0x4000
    s_cbranch_scc1 Lpp26
Lpp26_0:
Lpp26d:
    s_mov_b32 s98, 0
    buffer_load_dwordx2 v[8:9], v6, s[64:67], s9 offen sc1
    buffer_load_dwordx2 v[10:11], v7, s[64:67], s9 offen sc1
Lpp27:
    s_waitcnt vmcnt(0)
    v_pk_max_u16 v24, v8, v9
    v_pk_max_u16 v25, v10, v11
    v_pk_max_u16 v24, v24, v25
    v_lshrrev_b32 v25, 16, v24
    v_max_u16 v24, v24, v25
    v_cmp_eq_u16 vcc, -1, v24
    s_cbranch_vccz Lpp27_0
    buffer_load_dwordx2 v[8:9], v6, s[64:67], s9 offen sc1
    buffer_load_dwordx2 v[10:11], v7, s[64:67], s9 offen sc1
    s_add_u32 s98, s98, 1
    s_cmp_lt_u32 s98, 0x4000
    s_cbranch_scc1 Lpp27
Lpp27_0:
Lpp27d:
Lxd25:
    v_lshlrev_b32 v16, 16, v8
    v_and_b32 v17, 0xffff0000, v8
    v_lshlrev_b32 v18, 16, v9
    v_and_b32 v19, 0xffff0000, v9
    v_lshlrev_b32 v20, 16, v10
    v_and_b32 v21, 0xffff0000, v10
    v_lshlrev_b32 v22, 16, v11
    v_and_b32 v23, 0xffff0000, v11
    v_add_f32 v24, v16, v17
    v_add_f32 v26, v18, v19
    v_mul_f32 v25, v16, v16
    v_add_f32 v24, v24, v26
    v_fmac_f32 v25, v17, v17
    v_fmac_f32 v25, v18, v18
    v_fmac_f32 v25, v19, v19
    s_mov_b32 exec_hi, 0xffff
    v_add_f32 v24, v24, v20
    v_fmac_f32 v25, v20, v20
    v_add_f32 v24, v24, v21
    v_fmac_f32 v25, v21, v21
    v_add_f32 v24, v24, v22
    v_fmac_f32 v25, v22, v22
    v_add_f32 v24, v24, v23
    v_fmac_f32 v25, v23, v23
    s_mov_b32 exec_hi, -1
    s_nop 1
    v_add_f32_dpp v24, v24, v24 row_shr:1 row_mask:0xf bank_mask:0xf bound_ctrl:0
    v_add_f32_dpp v25, v25, v25 row_shr:1 row_mask:0xf bank_mask:0xf bound_ctrl:0
    s_nop 0
    v_add_f32_dpp v24, v24, v24 row_shr:2 row_mask:0xf bank_mask:0xf bound_ctrl:0
    v_add_f32_dpp v25, v25, v25 row_shr:2 row_mask:0xf bank_mask:0xf bound_ctrl:0
    s_nop 0
    v_add_f32_dpp v24, v24, v24 row_shr:4 row_mask:0xf bank_mask:0xf bound_ctrl:0
    v_add_f32_dpp v25, v25, v25 row_shr:4 row_mask:0xf bank_mask:0xf bound_ctrl:0
    s_nop 0
    v_add_f32_dpp v24, v24, v24 row_shr:8 row_mask:0xf bank_mask:0xf bound_ctrl:0
    v_add_f32_dpp v25, v25, v25 row_shr:8 row_mask:0xf bank_mask:0xf bound_ctrl:0
    s_nop 0
    v_add_f32_dpp v24, v24, v24 row_bcast:15 row_mask:0xa bank_mask:0xf
    v_add_f32_dpp v25, v25, v25 row_bcast:15 row_mask:0xa bank_mask:0xf
    s_nop 0
    v_add_f32_dpp v24, v24, v24 row_bcast:31 row_mask:0xc bank_mask:0xf
    v_add_f32_dpp v25, v25, v25 row_bcast:31 row_mask:0xc bank_mask:0xf
    s_nop 0
    v_readlane_b32 s8, v24, 63
    v_readlane_b32 s9, v25, 63
    s_mul_i32 s10, s7, 1088
    s_add_u32 s10, s10, 0
    v_mov_b32 v26, 0x3b124925
    v_mul_f32 v24, s8, v26
    v_mul_f32 v25, s9, v26
    v_fma_f32 v25, -v24, v24, v25
    v_max_f32 v25, 0, v25
    v_cvt_pk_bf16_f32 v26, v24, v25
    v_lshlrev_b32 v24, 16, v26
    v_and_b32 v25, 0xffff0000, v26
    v_add_f32 v25, 0x3727c5ac, v25
    v_cvt_pk_bf16_f32 v25, v25, v25
    v_lshlrev_b32 v25, 16, v25
    v_sqrt_f32 v25, v25
    v_sub_f32 v16, v16, v24
    v_sub_f32 v17, v17, v24
    v_sub_f32 v18, v18, v24
    v_sub_f32 v19, v19, v24
    v_sub_f32 v20, v20, v24
    v_sub_f32 v21, v21, v24
    v_sub_f32 v22, v22, v24
    v_sub_f32 v23, v23, v24
    v_cvt_pk_bf16_f32 v25, v25, v25
    v_lshlrev_b32 v25, 16, v25
    v_rcp_f32 v25, v25
    v_cvt_pk_bf16_f32 v26, v16, v17
    v_lshlrev_b32 v16, 16, v26
    v_and_b32 v17, 0xffff0000, v26
    v_cvt_pk_bf16_f32 v26, v18, v19
    v_lshlrev_b32 v18, 16, v26
    v_and_b32 v19, 0xffff0000, v26
    v_cvt_pk_bf16_f32 v26, v20, v21
    v_lshlrev_b32 v20, 16, v26
    v_and_b32 v21, 0xffff0000, v26
    v_cvt_pk_bf16_f32 v26, v22, v23
    v_lshlrev_b32 v22, 16, v26
    v_and_b32 v23, 0xffff0000, v26
    v_mul_f32 v16, v16, v25
    v_mul_f32 v17, v17, v25
    v_mul_f32 v18, v18, v25
    v_mul_f32 v19, v19, v25
    v_mul_f32 v20, v20, v25
    v_mul_f32 v21, v21, v25
    v_mul_f32 v22, v22, v25
    v_mul_f32 v23, v23, v25
    v_cvt_pk_bf16_f32 v24, v16, v17
    v_cvt_pk_bf16_f32 v25, v18, v19
    v_cvt_pk_bf16_f32 v26, v20, v21
    v_cvt_pk_bf16_f32 v27, v22, v23
    v_lshrrev_b32 v1, 1, v1
    v_add_u32 v1, s10, v1
    v_lshrrev_b32 v2, 1, v2
    v_add_u32 v2, s10, v2
    ds_write_b64 v1, v[24:25]
    ds_write_b64 v2, v[26:27]
    v_bfe_u32 v1, v0, 2, 2
    v_mul_u32_u24 v1, 1088, v1
    v_bfe_u32 v2, v0, 4, 2
    v_lshl_add_u32 v1, v2, 4, v1
    s_waitcnt lgkmcnt(0)
    s_barrier
    ds_read_b128 v[32:35], v1 offset:0
    ds_read_b128 v[36:39], v1 offset:64
    ds_read_b128 v[40:43], v1 offset:128
    ds_read_b128 v[44:47], v1 offset:192
    ds_read_b128 v[48:51], v1 offset:256
    ds_read_b128 v[52:55], v1 offset:320
    ds_read_b128 v[56:59], v1 offset:384
    ds_read_b128 v[60:63], v1 offset:448
    s_waitcnt lgkmcnt(7)
    v_mfma_f32_16x16x32_bf16 v[24:27], v[32:35], v[80:83], 0
    ds_read_b128 v[32:35], v1 offset:512
    s_waitcnt lgkmcnt(7)
    v_mfma_f32_16x16x32_bf16 v[28:31], v[36:39], v[84:87], 0
    ds_read_b128 v[36:39], v1 offset:576
    s_waitcnt lgkmcnt(7)
    v_mfma_f32_16x16x32_bf16 v[24:27], v[40:43], v[88:91], v[24:27]
    ds_read_b128 v[40:43], v1 offset:640
    s_waitcnt lgkmcnt(7)
    v_mfma_f32_16x16x32_bf16 v[28:31], v[44:47], v[92:95], v[28:31]
    ds_read_b128 v[44:47], v1 offset:704
    s_waitcnt lgkmcnt(7)
    v_mfma_f32_16x16x32_bf16 v[24:27], v[48:51], v[96:99], v[24:27]
    ds_read_b128 v[48:51], v1 offset:768
    s_waitcnt lgkmcnt(7)
    v_mfma_f32_16x16x32_bf16 v[28:31], v[52:55], v[100:103], v[28:31]
    ds_read_b128 v[52:55], v1 offset:832
    s_waitcnt lgkmcnt(7)
    v_mfma_f32_16x16x32_bf16 v[24:27], v[56:59], v[104:107], v[24:27]
    s_waitcnt lgkmcnt(6)
    v_mfma_f32_16x16x32_bf16 v[28:31], v[60:63], v[108:111], v[28:31]
    s_waitcnt lgkmcnt(5)
    v_mfma_f32_16x16x32_bf16 v[24:27], v[32:35], v[112:115], v[24:27]
    s_waitcnt lgkmcnt(4)
    v_mfma_f32_16x16x32_bf16 v[28:31], v[36:39], v[116:119], v[28:31]
    s_waitcnt lgkmcnt(3)
    v_mfma_f32_16x16x32_bf16 v[24:27], v[40:43], v[120:123], v[24:27]
    s_waitcnt lgkmcnt(2)
    v_mfma_f32_16x16x32_bf16 v[28:31], v[44:47], v[124:127], v[28:31]
    s_waitcnt lgkmcnt(1)
    v_mfma_f32_16x16x32_bf16 v[24:27], v[48:51], v[128:131], v[24:27]
    s_waitcnt lgkmcnt(0)
    v_mfma_f32_16x16x32_bf16 v[28:31], v[52:55], v[132:135], v[28:31]
    v_bfe_u32 v1, v0, 4, 2
    v_and_b32 v2, 15, v0
    s_nop 6
    v_add_f32 v24, v24, v28
    s_bitcmp1_b32 s2, 0
    s_cbranch_scc1 Lnogelu
    v_cvt_pk_bf16_f32 v24, v24, v24
    v_lshlrev_b32 v24, 16, v24
    v_mul_f32 v26, v24, v24
    v_mov_b32 v25, 0xc0135761
    v_fmac_f32 v25, 0xbdd2d3e8, v26
    v_mul_f32 v25, v25, v24
    v_exp_f32 v25, v25
    s_nop 0
    v_add_f32 v25, 1.0, v25
    v_rcp_f32 v25, v25
    s_nop 0
    v_mul_f32 v24, v25, v24
Lnogelu:
    v_lshlrev_b32 v1, 12, v1
    v_lshl_add_u32 v1, v2, 1, v1
    v_mov_b32_dpp v26, v24 quad_perm:[1,0,3,2] row_mask:0xf bank_mask:0xf
    s_add_u32 s8, s86, s87
    s_mov_b32 exec_lo, 0x55555555
    s_mov_b32 exec_hi, 0x55555555
    v_cvt_pk_bf16_f32 v24, v24, v26
    v_min_u32 v24, -2, v24
    buffer_store_dword v24, v1, s[64:67], s8 offen sc1
    s_mov_b64 exec, -1
    s_branch Lnextg
Lq:
    s_cmp_lg_u32 s3, 0
    s_cbranch_scc1 Lend
    v_and_b32 v15, 63, v0
    v_lshlrev_b32 v1, 4, v15
    v_min_u32 v2, 47, v15
    v_lshlrev_b32 v2, 4, v2
    v_add_u32 v2, 1024, v2
    s_mul_i32 s8, s7, 896
    s_add_u32 s8, s8, 12544
    v_lshrrev_b32 v3, 1, v1
    v_add_u32 v3, s8, v3
    v_lshrrev_b32 v14, 1, v2
    v_add_u32 v14, s8, v14
    v_lshrrev_b32 v6, 1, v1
    v_lshrrev_b32 v7, 1, v2
    s_mul_i32 s9, s7, 896
    s_add_u32 s9, s9, 0x52000
    s_add_u32 s9, s9, s56
    s_lshr_b32 s8, s2, 1
    s_and_b32 s8, s8, 7
    s_min_u32 s8, s8, 6
    s_lshl_b32 s8, s8, 7
    s_add_u32 s10, s9, s8
    v_mov_b32 v25, 0
    s_mov_b32 s98, 0
    buffer_load_ushort v72, v25, s[64:67], s10 offen sc1
Lpp29:
    s_waitcnt vmcnt(0)
    v_cmp_eq_u16 vcc, -1, v72
    s_cbranch_vccz Lpp29_0
    buffer_load_ushort v72, v25, s[64:67], s10 offen sc1
    s_add_u32 s98, s98, 1
    s_cmp_lt_u32 s98, 0x4000
    s_cbranch_scc1 Lpp29
Lpp29_0:
Lpp29d:
    s_mov_b32 s98, 0
    buffer_load_dwordx2 v[8:9], v6, s[64:67], s9 offen sc1
    buffer_load_dwordx2 v[10:11], v7, s[64:67], s9 offen sc1
Lpp30:
    s_waitcnt vmcnt(0)
    v_pk_max_u16 v24, v8, v9
    v_pk_max_u16 v25, v10, v11
    v_pk_max_u16 v24, v24, v25
    v_lshrrev_b32 v25, 16, v24
    v_max_u16 v24, v24, v25
    v_cmp_eq_u16 vcc, -1, v24
    s_cbranch_vccz Lpp30_0
    buffer_load_dwordx2 v[8:9], v6, s[64:67], s9 offen sc1
    buffer_load_dwordx2 v[10:11], v7, s[64:67], s9 offen sc1
    s_add_u32 s98, s98, 1
    s_cmp_lt_u32 s98, 0x4000
    s_cbranch_scc1 Lpp30
Lpp30_0:
Lpp30d:
Lxd28:
    v_lshlrev_b32 v16, 16, v8
    v_and_b32 v17, 0xffff0000, v8
    v_lshlrev_b32 v18, 16, v9
    v_and_b32 v19, 0xffff0000, v9
    v_lshlrev_b32 v20, 16, v10
    v_and_b32 v21, 0xffff0000, v10
    v_lshlrev_b32 v22, 16, v11
    v_and_b32 v23, 0xffff0000, v11
    v_add_f32 v24, v16, v17
    v_add_f32 v26, v18, v19
    v_mul_f32 v25, v16, v16
    v_add_f32 v24, v24, v26
    v_fmac_f32 v25, v17, v17
    v_fmac_f32 v25, v18, v18
    v_fmac_f32 v25, v19, v19
    s_mov_b32 exec_hi, 0xffff
    v_add_f32 v24, v24, v20
    v_fmac_f32 v25, v20, v20
    v_add_f32 v24, v24, v21
    v_fmac_f32 v25, v21, v21
    v_add_f32 v24, v24, v22
    v_fmac_f32 v25, v22, v22
    v_add_f32 v24, v24, v23
    v_fmac_f32 v25, v23, v23
    s_mov_b32 exec_hi, -1
    s_nop 1
    v_add_f32_dpp v24, v24, v24 row_shr:1 row_mask:0xf bank_mask:0xf bound_ctrl:0
    v_add_f32_dpp v25, v25, v25 row_shr:1 row_mask:0xf bank_mask:0xf bound_ctrl:0
    s_nop 0
    v_add_f32_dpp v24, v24, v24 row_shr:2 row_mask:0xf bank_mask:0xf bound_ctrl:0
    v_add_f32_dpp v25, v25, v25 row_shr:2 row_mask:0xf bank_mask:0xf bound_ctrl:0
    s_nop 0
    v_add_f32_dpp v24, v24, v24 row_shr:4 row_mask:0xf bank_mask:0xf bound_ctrl:0
    v_add_f32_dpp v25, v25, v25 row_shr:4 row_mask:0xf bank_mask:0xf bound_ctrl:0
    s_nop 0
    v_add_f32_dpp v24, v24, v24 row_shr:8 row_mask:0xf bank_mask:0xf bound_ctrl:0
    v_add_f32_dpp v25, v25, v25 row_shr:8 row_mask:0xf bank_mask:0xf bound_ctrl:0
    s_nop 0
    v_add_f32_dpp v24, v24, v24 row_bcast:15 row_mask:0xa bank_mask:0xf
    v_add_f32_dpp v25, v25, v25 row_bcast:15 row_mask:0xa bank_mask:0xf
    s_nop 0
    v_add_f32_dpp v24, v24, v24 row_bcast:31 row_mask:0xc bank_mask:0xf
    v_add_f32_dpp v25, v25, v25 row_bcast:31 row_mask:0xc bank_mask:0xf
    s_nop 0
    v_readlane_b32 s8, v24, 63
    v_readlane_b32 s9, v25, 63
    s_mul_i32 s10, s7, 1088
    s_add_u32 s10, s10, 0
    v_mov_b32 v26, 0x3b124925
    v_mul_f32 v24, s8, v26
    v_mul_f32 v25, s9, v26
    v_fma_f32 v25, -v24, v24, v25
    v_max_f32 v25, 0, v25
    v_cvt_pk_bf16_f32 v26, v24, v25
    v_lshlrev_b32 v24, 16, v26
    v_and_b32 v25, 0xffff0000, v26
    v_add_f32 v25, 0x3727c5ac, v25
    v_cvt_pk_bf16_f32 v25, v25, v25
    v_lshlrev_b32 v25, 16, v25
    v_sqrt_f32 v25, v25
    v_sub_f32 v16, v16, v24
    v_sub_f32 v17, v17, v24
    v_sub_f32 v18, v18, v24
    v_sub_f32 v19, v19, v24
    v_sub_f32 v20, v20, v24
    v_sub_f32 v21, v21, v24
    v_sub_f32 v22, v22, v24
    v_sub_f32 v23, v23, v24
    v_cvt_pk_bf16_f32 v25, v25, v25
    v_lshlrev_b32 v25, 16, v25
    v_rcp_f32 v25, v25
    v_cvt_pk_bf16_f32 v26, v16, v17
    v_lshlrev_b32 v16, 16, v26
    v_and_b32 v17, 0xffff0000, v26
    v_cvt_pk_bf16_f32 v26, v18, v19
    v_lshlrev_b32 v18, 16, v26
    v_and_b32 v19, 0xffff0000, v26
    v_cvt_pk_bf16_f32 v26, v20, v21
    v_lshlrev_b32 v20, 16, v26
    v_and_b32 v21, 0xffff0000, v26
    v_cvt_pk_bf16_f32 v26, v22, v23
    v_lshlrev_b32 v22, 16, v26
    v_and_b32 v23, 0xffff0000, v26
    v_mul_f32 v16, v16, v25
    v_mul_f32 v17, v17, v25
    v_mul_f32 v18, v18, v25
    v_mul_f32 v19, v19, v25
    v_mul_f32 v20, v20, v25
    v_mul_f32 v21, v21, v25
    v_mul_f32 v22, v22, v25
    v_mul_f32 v23, v23, v25
    v_cvt_pk_bf16_f32 v24, v16, v17
    v_cvt_pk_bf16_f32 v25, v18, v19
    v_cvt_pk_bf16_f32 v26, v20, v21
    v_cvt_pk_bf16_f32 v27, v22, v23
    v_lshrrev_b32 v1, 1, v1
    v_add_u32 v1, s10, v1
    v_lshrrev_b32 v2, 1, v2
    v_add_u32 v2, s10, v2
    ds_write_b64 v1, v[24:25]
    ds_write_b64 v2, v[26:27]
    s_mov_b32 s82, 0x48000
    v_bfe_u32 v1, v0, 2, 2
    v_mul_u32_u24 v1, 1088, v1
    v_bfe_u32 v2, v0, 4, 2
    v_lshl_add_u32 v1, v2, 4, v1
    s_waitcnt lgkmcnt(0)
    s_barrier
    ds_read_b128 v[32:35], v1 offset:0
    ds_read_b128 v[36:39], v1 offset:64
    ds_read_b128 v[40:43], v1 offset:128
    ds_read_b128 v[44:47], v1 offset:192
    ds_read_b128 v[48:51], v1 offset:256
    ds_read_b128 v[52:55], v1 offset:320
    ds_read_b128 v[56:59], v1 offset:384
    ds_read_b128 v[60:63], v1 offset:448
    s_waitcnt lgkmcnt(7)
    v_mfma_f32_16x16x32_bf16 v[24:27], v[32:35], v[80:83], 0
    ds_read_b128 v[32:35], v1 offset:512
    s_waitcnt lgkmcnt(7)
    v_mfma_f32_16x16x32_bf16 v[28:31], v[36:39], v[84:87], 0
    ds_read_b128 v[36:39], v1 offset:576
    s_waitcnt lgkmcnt(7)
    v_mfma_f32_16x16x32_bf16 v[24:27], v[40:43], v[88:91], v[24:27]
    ds_read_b128 v[40:43], v1 offset:640
    s_waitcnt lgkmcnt(7)
    v_mfma_f32_16x16x32_bf16 v[28:31], v[44:47], v[92:95], v[28:31]
    ds_read_b128 v[44:47], v1 offset:704
    s_waitcnt lgkmcnt(7)
    v_mfma_f32_16x16x32_bf16 v[24:27], v[48:51], v[96:99], v[24:27]
    ds_read_b128 v[48:51], v1 offset:768
    s_waitcnt lgkmcnt(7)
    v_mfma_f32_16x16x32_bf16 v[28:31], v[52:55], v[100:103], v[28:31]
    ds_read_b128 v[52:55], v1 offset:832
    s_waitcnt lgkmcnt(7)
    v_mfma_f32_16x16x32_bf16 v[24:27], v[56:59], v[104:107], v[24:27]
    s_waitcnt lgkmcnt(6)
    v_mfma_f32_16x16x32_bf16 v[28:31], v[60:63], v[108:111], v[28:31]
    s_waitcnt lgkmcnt(5)
    v_mfma_f32_16x16x32_bf16 v[24:27], v[32:35], v[112:115], v[24:27]
    s_waitcnt lgkmcnt(4)
    v_mfma_f32_16x16x32_bf16 v[28:31], v[36:39], v[116:119], v[28:31]
    s_waitcnt lgkmcnt(3)
    v_mfma_f32_16x16x32_bf16 v[24:27], v[40:43], v[120:123], v[24:27]
    s_waitcnt lgkmcnt(2)
    v_mfma_f32_16x16x32_bf16 v[28:31], v[44:47], v[124:127], v[28:31]
    s_waitcnt lgkmcnt(1)
    v_mfma_f32_16x16x32_bf16 v[24:27], v[48:51], v[128:131], v[24:27]
    s_waitcnt lgkmcnt(0)
    v_mfma_f32_16x16x32_bf16 v[28:31], v[52:55], v[132:135], v[28:31]
    v_bfe_u32 v1, v0, 4, 2
    v_and_b32 v2, 15, v0
    s_nop 6
    v_add_f32 v24, v24, v28
    s_nop 1
    v_mov_b32_dpp v25, v24 quad_perm:[1,0,3,2] row_mask:0xf bank_mask:0xf
    v_cvt_pk_bf16_f32 v24, v24, v25
    v_min_u32 v24, -2, v24
    v_lshlrev_b32 v1, 13, v1
    v_lshl_add_u32 v1, v2, 1, v1
    s_add_u32 s8, s82, s83
    s_mov_b32 exec_lo, 0x55555555
    s_mov_b32 exec_hi, 0x55555555
    buffer_store_dword v24, v1, s[64:67], s8 offen sc1
    s_mov_b64 exec, -1
    s_branch Lnext
Lf:
    s_cmp_eq_u32 s3, 0
    s_cbranch_scc1 Lnexts
    s_branch Lend
    s_cmp_lg_u32 s2, 255
    s_cbranch_scc1 Lend
    v_and_b32 v15, 63, v0
    v_lshlrev_b32 v1, 4, v15
    v_min_u32 v2, 47, v15
    v_lshlrev_b32 v2, 4, v2
    v_add_u32 v2, 1024, v2
    s_mul_i32 s8, s7, 896
    s_add_u32 s8, s8, 12544
    v_lshrrev_b32 v3, 1, v1
    v_add_u32 v3, s8, v3
    v_lshrrev_b32 v14, 1, v2
    v_add_u32 v14, s8, v14
    ds_read_b64 v[8:9], v3
    ds_read_b64 v[10:11], v14
    v_lshlrev_b32 v6, 1, v1
    v_lshlrev_b32 v7, 1, v2
    s_add_u32 s9, s15, 0x60000
    s_add_u32 s10, s15, 0x70000
    s_mov_b32 s98, 0
Lpoll31:
    buffer_load_dwordx4 v[32:35], v6, s[64:67], s9 offen offset:0 sc1
    buffer_load_dwordx4 v[36:39], v6, s[64:67], s9 offen offset:16 sc1
    buffer_load_dwordx4 v[40:43], v7, s[64:67], s9 offen offset:0 sc1
    buffer_load_dwordx4 v[44:47], v7, s[64:67], s9 offen offset:16 sc1
    buffer_load_dwordx4 v[48:51], v6, s[64:67], s10 offen offset:0 sc1
    buffer_load_dwordx4 v[52:55], v6, s[64:67], s10 offen offset:16 sc1
    buffer_load_dwordx4 v[56:59], v7, s[64:67], s10 offen offset:0 sc1
    buffer_load_dwordx4 v[60:63], v7, s[64:67], s10 offen offset:16 sc1
    s_waitcnt vmcnt(0)
    v_and_b32 v24, v32, v34
    v_and_b32 v25, v36, v38
    v_and_b32 v26, v40, v42
    v_and_b32 v27, v44, v46
    v_and_b32 v24, v24, v25
    v_and_b32 v26, v26, v27
    v_and_b32 v24, v24, v26
    v_and_b32 v28, 16, v24
    v_and_b32 v24, v48, v50
    v_and_b32 v25, v52, v54
    v_and_b32 v26, v56, v58
    v_and_b32 v27, v60, v62
    v_and_b32 v24, v24, v25
    v_and_b32 v26, v26, v27
    v_and_b32 v24, v24, v26
    v_and_b32 v29, 8, v24
    v_min_u32 v28, v28, v29
    v_cmp_eq_u32 vcc, 0, v28
    s_cbranch_vccz Lpoll31d
    s_add_u32 s98, s98, 1
    s_cmp_lt_u32 s98, 0x8000
    s_cbranch_scc1 Lpoll31
Lpoll31d:
    s_waitcnt lgkmcnt(0)
    v_lshrrev_b32 v16, 31, v32
    v_cvt_f32_i32 v32, v32
    v_lshrrev_b32 v17, 31, v34
    v_cvt_f32_i32 v34, v34
    v_lshrrev_b32 v18, 31, v36
    v_cvt_f32_i32 v36, v36
    v_lshrrev_b32 v19, 31, v38
    v_cvt_f32_i32 v38, v38
    v_lshrrev_b32 v20, 31, v40
    v_cvt_f32_i32 v40, v40
    v_lshrrev_b32 v21, 31, v42
    v_cvt_f32_i32 v42, v42
    v_lshrrev_b32 v22, 31, v44
    v_cvt_f32_i32 v44, v44
    v_lshrrev_b32 v23, 31, v46
    v_cvt_f32_i32 v46, v46
    v_add_u32 v16, v16, v33
    v_add_u32 v17, v17, v35
    v_add_u32 v18, v18, v37
    v_add_u32 v19, v19, v39
    v_add_u32 v20, v20, v41
    v_add_u32 v21, v21, v43
    v_add_u32 v22, v22, v45
    v_add_u32 v23, v23, v47
    v_cvt_f32_i32 v16, v16
    v_cvt_f32_i32 v17, v17
    v_cvt_f32_i32 v18, v18
    v_cvt_f32_i32 v19, v19
    v_cvt_f32_i32 v20, v20
    v_cvt_f32_i32 v21, v21
    v_cvt_f32_i32 v22, v22
    v_cvt_f32_i32 v23, v23
    v_fmac_f32 v16, s97, v32
    v_fmac_f32 v17, s97, v34
    v_fmac_f32 v18, s97, v36
    v_fmac_f32 v19, s97, v38
    v_fmac_f32 v20, s97, v40
    v_fmac_f32 v21, s97, v42
    v_fmac_f32 v22, s97, v44
    v_fmac_f32 v23, s97, v46
    v_cvt_pk_bf16_f32 v24, v16, v17
    v_lshlrev_b32 v25, 16, v24
    v_and_b32 v26, 0xffff0000, v24
    v_lshlrev_b32 v27, 16, v8
    v_and_b32 v28, 0xffff0000, v8
    v_add_f32 v25, v25, v27
    v_add_f32 v26, v26, v28
    v_cvt_pk_bf16_f32 v8, v25, v26
    v_cvt_pk_bf16_f32 v24, v18, v19
    v_lshlrev_b32 v25, 16, v24
    v_and_b32 v26, 0xffff0000, v24
    v_lshlrev_b32 v27, 16, v9
    v_and_b32 v28, 0xffff0000, v9
    v_add_f32 v25, v25, v27
    v_add_f32 v26, v26, v28
    v_cvt_pk_bf16_f32 v9, v25, v26
    v_cvt_pk_bf16_f32 v24, v20, v21
    v_lshlrev_b32 v25, 16, v24
    v_and_b32 v26, 0xffff0000, v24
    v_lshlrev_b32 v27, 16, v10
    v_and_b32 v28, 0xffff0000, v10
    v_add_f32 v25, v25, v27
    v_add_f32 v26, v26, v28
    v_cvt_pk_bf16_f32 v10, v25, v26
    v_cvt_pk_bf16_f32 v24, v22, v23
    v_lshlrev_b32 v25, 16, v24
    v_and_b32 v26, 0xffff0000, v24
    v_lshlrev_b32 v27, 16, v11
    v_and_b32 v28, 0xffff0000, v11
    v_add_f32 v25, v25, v27
    v_add_f32 v26, v26, v28
    v_cvt_pk_bf16_f32 v11, v25, v26
    v_lshrrev_b32 v16, 31, v48
    v_cvt_f32_i32 v48, v48
    v_lshrrev_b32 v17, 31, v50
    v_cvt_f32_i32 v50, v50
    v_lshrrev_b32 v18, 31, v52
    v_cvt_f32_i32 v52, v52
    v_lshrrev_b32 v19, 31, v54
    v_cvt_f32_i32 v54, v54
    v_lshrrev_b32 v20, 31, v56
    v_cvt_f32_i32 v56, v56
    v_lshrrev_b32 v21, 31, v58
    v_cvt_f32_i32 v58, v58
    v_lshrrev_b32 v22, 31, v60
    v_cvt_f32_i32 v60, v60
    v_lshrrev_b32 v23, 31, v62
    v_cvt_f32_i32 v62, v62
    v_add_u32 v16, v16, v49
    v_add_u32 v17, v17, v51
    v_add_u32 v18, v18, v53
    v_add_u32 v19, v19, v55
    v_add_u32 v20, v20, v57
    v_add_u32 v21, v21, v59
    v_add_u32 v22, v22, v61
    v_add_u32 v23, v23, v63
    v_cvt_f32_i32 v16, v16
    v_cvt_f32_i32 v17, v17
    v_cvt_f32_i32 v18, v18
    v_cvt_f32_i32 v19, v19
    v_cvt_f32_i32 v20, v20
    v_cvt_f32_i32 v21, v21
    v_cvt_f32_i32 v22, v22
    v_cvt_f32_i32 v23, v23
    v_fmac_f32 v16, s97, v48
    v_fmac_f32 v17, s97, v50
    v_fmac_f32 v18, s97, v52
    v_fmac_f32 v19, s97, v54
    v_fmac_f32 v20, s97, v56
    v_fmac_f32 v21, s97, v58
    v_fmac_f32 v22, s97, v60
    v_fmac_f32 v23, s97, v62
    v_cvt_pk_bf16_f32 v24, v16, v17
    v_lshlrev_b32 v25, 16, v24
    v_and_b32 v26, 0xffff0000, v24
    v_lshlrev_b32 v27, 16, v8
    v_and_b32 v28, 0xffff0000, v8
    v_add_f32 v25, v25, v27
    v_add_f32 v26, v26, v28
    v_cvt_pk_bf16_f32 v8, v25, v26
    v_cvt_pk_bf16_f32 v24, v18, v19
    v_lshlrev_b32 v25, 16, v24
    v_and_b32 v26, 0xffff0000, v24
    v_lshlrev_b32 v27, 16, v9
    v_and_b32 v28, 0xffff0000, v9
    v_add_f32 v25, v25, v27
    v_add_f32 v26, v26, v28
    v_cvt_pk_bf16_f32 v9, v25, v26
    v_cvt_pk_bf16_f32 v24, v20, v21
    v_lshlrev_b32 v25, 16, v24
    v_and_b32 v26, 0xffff0000, v24
    v_lshlrev_b32 v27, 16, v10
    v_and_b32 v28, 0xffff0000, v10
    v_add_f32 v25, v25, v27
    v_add_f32 v26, v26, v28
    v_cvt_pk_bf16_f32 v10, v25, v26
    v_cvt_pk_bf16_f32 v24, v22, v23
    v_lshlrev_b32 v25, 16, v24
    v_and_b32 v26, 0xffff0000, v24
    v_lshlrev_b32 v27, 16, v11
    v_and_b32 v28, 0xffff0000, v11
    v_add_f32 v25, v25, v27
    v_add_f32 v26, v26, v28
    v_cvt_pk_bf16_f32 v11, v25, v26
    s_add_u32 s9, s15, 0xe0000
    s_mov_b32 s98, 0
Lpoll32:
    buffer_load_dwordx4 v[32:35], v6, s[64:67], s9 offen offset:0 sc1
    buffer_load_dwordx4 v[36:39], v6, s[64:67], s9 offen offset:16 sc1
    buffer_load_dwordx4 v[40:43], v7, s[64:67], s9 offen offset:0 sc1
    buffer_load_dwordx4 v[44:47], v7, s[64:67], s9 offen offset:16 sc1
    s_waitcnt vmcnt(0)
    v_and_b32 v24, v32, v34
    v_and_b32 v25, v36, v38
    v_and_b32 v26, v40, v42
    v_and_b32 v27, v44, v46
    v_and_b32 v24, v24, v25
    v_and_b32 v26, v26, v27
    v_and_b32 v24, v24, v26
    v_and_b32 v28, 16, v24
    v_cmp_eq_u32 vcc, 0, v28
    s_cbranch_vccz Lpoll32d
    s_sleep 8
    s_add_u32 s98, s98, 1
    s_cmp_lt_u32 s98, 0x8000
    s_cbranch_scc1 Lpoll32
Lpoll32d:
    s_waitcnt lgkmcnt(0)
    v_lshrrev_b32 v16, 31, v32
    v_cvt_f32_i32 v32, v32
    v_lshrrev_b32 v17, 31, v34
    v_cvt_f32_i32 v34, v34
    v_lshrrev_b32 v18, 31, v36
    v_cvt_f32_i32 v36, v36
    v_lshrrev_b32 v19, 31, v38
    v_cvt_f32_i32 v38, v38
    v_lshrrev_b32 v20, 31, v40
    v_cvt_f32_i32 v40, v40
    v_lshrrev_b32 v21, 31, v42
    v_cvt_f32_i32 v42, v42
    v_lshrrev_b32 v22, 31, v44
    v_cvt_f32_i32 v44, v44
    v_lshrrev_b32 v23, 31, v46
    v_cvt_f32_i32 v46, v46
    v_add_u32 v16, v16, v33
    v_add_u32 v17, v17, v35
    v_add_u32 v18, v18, v37
    v_add_u32 v19, v19, v39
    v_add_u32 v20, v20, v41
    v_add_u32 v21, v21, v43
    v_add_u32 v22, v22, v45
    v_add_u32 v23, v23, v47
    v_cvt_f32_i32 v16, v16
    v_cvt_f32_i32 v17, v17
    v_cvt_f32_i32 v18, v18
    v_cvt_f32_i32 v19, v19
    v_cvt_f32_i32 v20, v20
    v_cvt_f32_i32 v21, v21
    v_cvt_f32_i32 v22, v22
    v_cvt_f32_i32 v23, v23
    v_fmac_f32 v16, s97, v32
    v_fmac_f32 v17, s97, v34
    v_fmac_f32 v18, s97, v36
    v_fmac_f32 v19, s97, v38
    v_fmac_f32 v20, s97, v40
    v_fmac_f32 v21, s97, v42
    v_fmac_f32 v22, s97, v44
    v_fmac_f32 v23, s97, v46
    v_cvt_pk_bf16_f32 v24, v16, v17
    v_lshlrev_b32 v25, 16, v24
    v_and_b32 v26, 0xffff0000, v24
    v_lshlrev_b32 v27, 16, v8
    v_and_b32 v28, 0xffff0000, v8
    v_add_f32 v25, v25, v27
    v_add_f32 v26, v26, v28
    v_cvt_pk_bf16_f32 v8, v25, v26
    v_cvt_pk_bf16_f32 v24, v18, v19
    v_lshlrev_b32 v25, 16, v24
    v_and_b32 v26, 0xffff0000, v24
    v_lshlrev_b32 v27, 16, v9
    v_and_b32 v28, 0xffff0000, v9
    v_add_f32 v25, v25, v27
    v_add_f32 v26, v26, v28
    v_cvt_pk_bf16_f32 v9, v25, v26
    v_cvt_pk_bf16_f32 v24, v20, v21
    v_lshlrev_b32 v25, 16, v24
    v_and_b32 v26, 0xffff0000, v24
    v_lshlrev_b32 v27, 16, v10
    v_and_b32 v28, 0xffff0000, v10
    v_add_f32 v25, v25, v27
    v_add_f32 v26, v26, v28
    v_cvt_pk_bf16_f32 v10, v25, v26
    v_cvt_pk_bf16_f32 v24, v22, v23
    v_lshlrev_b32 v25, 16, v24
    v_and_b32 v26, 0xffff0000, v24
    v_lshlrev_b32 v27, 16, v11
    v_and_b32 v28, 0xffff0000, v11
    v_add_f32 v25, v25, v27
    v_add_f32 v26, v26, v28
    v_cvt_pk_bf16_f32 v11, v25, v26
    s_add_u32 s9, s15, 0xf0000
    s_mov_b32 s98, 0
Lpoll33:
    buffer_load_dwordx4 v[32:35], v6, s[64:67], s9 offen offset:0 sc1
    buffer_load_dwordx4 v[36:39], v6, s[64:67], s9 offen offset:16 sc1
    buffer_load_dwordx4 v[40:43], v7, s[64:67], s9 offen offset:0 sc1
    buffer_load_dwordx4 v[44:47], v7, s[64:67], s9 offen offset:16 sc1
    s_waitcnt vmcnt(0)
    v_and_b32 v24, v32, v34
    v_and_b32 v25, v36, v38
    v_and_b32 v26, v40, v42
    v_and_b32 v27, v44, v46
    v_and_b32 v24, v24, v25
    v_and_b32 v26, v26, v27
    v_and_b32 v24, v24, v26
    v_and_b32 v28, 8, v24
    v_cmp_eq_u32 vcc, 0, v28
    s_cbranch_vccz Lpoll33d
    s_add_u32 s98, s98, 1
    s_cmp_lt_u32 s98, 0x8000
    s_cbranch_scc1 Lpoll33
Lpoll33d:
    s_waitcnt lgkmcnt(0)
    v_lshrrev_b32 v16, 31, v32
    v_cvt_f32_i32 v32, v32
    v_lshrrev_b32 v17, 31, v34
    v_cvt_f32_i32 v34, v34
    v_lshrrev_b32 v18, 31, v36
    v_cvt_f32_i32 v36, v36
    v_lshrrev_b32 v19, 31, v38
    v_cvt_f32_i32 v38, v38
    v_lshrrev_b32 v20, 31, v40
    v_cvt_f32_i32 v40, v40
    v_lshrrev_b32 v21, 31, v42
    v_cvt_f32_i32 v42, v42
    v_lshrrev_b32 v22, 31, v44
    v_cvt_f32_i32 v44, v44
    v_lshrrev_b32 v23, 31, v46
    v_cvt_f32_i32 v46, v46
    v_add_u32 v16, v16, v33
    v_add_u32 v17, v17, v35
    v_add_u32 v18, v18, v37
    v_add_u32 v19, v19, v39
    v_add_u32 v20, v20, v41
    v_add_u32 v21, v21, v43
    v_add_u32 v22, v22, v45
    v_add_u32 v23, v23, v47
    v_cvt_f32_i32 v16, v16
    v_cvt_f32_i32 v17, v17
    v_cvt_f32_i32 v18, v18
    v_cvt_f32_i32 v19, v19
    v_cvt_f32_i32 v20, v20
    v_cvt_f32_i32 v21, v21
    v_cvt_f32_i32 v22, v22
    v_cvt_f32_i32 v23, v23
    v_fmac_f32 v16, s97, v32
    v_fmac_f32 v17, s97, v34
    v_fmac_f32 v18, s97, v36
    v_fmac_f32 v19, s97, v38
    v_fmac_f32 v20, s97, v40
    v_fmac_f32 v21, s97, v42
    v_fmac_f32 v22, s97, v44
    v_fmac_f32 v23, s97, v46
    v_cvt_pk_bf16_f32 v24, v16, v17
    v_lshlrev_b32 v25, 16, v24
    v_and_b32 v26, 0xffff0000, v24
    v_lshlrev_b32 v27, 16, v8
    v_and_b32 v28, 0xffff0000, v8
    v_add_f32 v25, v25, v27
    v_add_f32 v26, v26, v28
    v_cvt_pk_bf16_f32 v8, v25, v26
    v_cvt_pk_bf16_f32 v24, v18, v19
    v_lshlrev_b32 v25, 16, v24
    v_and_b32 v26, 0xffff0000, v24
    v_lshlrev_b32 v27, 16, v9
    v_and_b32 v28, 0xffff0000, v9
    v_add_f32 v25, v25, v27
    v_add_f32 v26, v26, v28
    v_cvt_pk_bf16_f32 v9, v25, v26
    v_cvt_pk_bf16_f32 v24, v20, v21
    v_lshlrev_b32 v25, 16, v24
    v_and_b32 v26, 0xffff0000, v24
    v_lshlrev_b32 v27, 16, v10
    v_and_b32 v28, 0xffff0000, v10
    v_add_f32 v25, v25, v27
    v_add_f32 v26, v26, v28
    v_cvt_pk_bf16_f32 v10, v25, v26
    v_cvt_pk_bf16_f32 v24, v22, v23
    v_lshlrev_b32 v25, 16, v24
    v_and_b32 v26, 0xffff0000, v24
    v_lshlrev_b32 v27, 16, v11
    v_and_b32 v28, 0xffff0000, v11
    v_add_f32 v25, v25, v27
    v_add_f32 v26, v26, v28
    v_cvt_pk_bf16_f32 v11, v25, v26
    v_lshrrev_b32 v1, 1, v1
    v_lshrrev_b32 v2, 1, v2
    s_mul_i32 s8, s7, 896
    buffer_store_dwordx2 v[8:9], v1, s[72:75], s8 offen
    s_mov_b32 exec_hi, 0xffff
    buffer_store_dwordx2 v[10:11], v2, s[72:75], s8 offen
    s_branch Lend
Lnexts:
Lnextg:
Lnext:
    s_cmp_lg_u32 s3, 0
    s_cbranch_scc1 Lend
    s_waitcnt vmcnt(0)
    s_mov_b32 s3, 1
    s_mov_b32 s86, 0x80000
    s_mov_b32 s82, 0x48000
    s_branch Lloop
Lend:
    s_endpgm
.section .rodata,"a"
.p2align 6
.amdhsa_kernel interleave_layers__gqa_block_cached__geglu_ffn__decode_kernel
  .amdhsa_next_free_vgpr 512
  .amdhsa_next_free_sgpr 102
  .amdhsa_accum_offset 256
  .amdhsa_group_segment_fixed_size 0
  .amdhsa_kernarg_size 96
  .amdhsa_user_sgpr_count 2
  .amdhsa_user_sgpr_kernarg_segment_ptr 1
  .amdhsa_system_sgpr_workgroup_id_x 1
.end_amdhsa_kernel
```
